```python
import torch

def _softmax(x, axis=-1):
    return torch.softmax(x, dim=axis)
def _gelu(x):
    return torch.nn.functional.gelu(x, approximate="tanh")
def _silu(x):
    return torch.nn.functional.silu(x)
def _sigmoid(x):
    return torch.sigmoid(x)
def _layernorm(x, axis=-1, eps=1e-5):
    m = x.mean(dim=axis, keepdim=True)
    v = x.var(dim=axis, keepdim=True, unbiased=False)
    return (x - m) / torch.sqrt(v + eps)
def _scatter_add(tgt, idx, src, axis=0):
    return tgt.clone().index_add_(axis, idx, src)
def _segment_sum(src, seg, n):
    out = torch.zeros((n,) + src.shape[1:], dtype=src.dtype)
    return out.index_add_(0, seg, src)
def _pad(x, pw):
    flat = tuple(v for pair in reversed(pw) for v in pair)
    return torch.nn.functional.pad(x, flat)

kernel_name = 'gated_mix__ssm_conv_s5__mixer_channel_mlp__prompt'

def setup_inputs():

    _w = (lambda a: (lambda t: t.to(torch.bfloat16) if t.is_floating_point() else t)(torch.as_tensor(a)))
    def _A_setup():
        B, S, D = 1, 2048, 512
        P = D
        Lambda_re = -0.5 * (lambda _x: torch.exp(torch.as_tensor(_x)))((lambda *s: torch.randn(*s, dtype=torch.bfloat16) * 0.4)(P))
        Lambda_im = (lambda *s: torch.randn(*s, dtype=torch.bfloat16) * 0.8)(P) * 1.0
        B_re = (lambda *s: torch.randn(*s, dtype=torch.bfloat16) * 0.8)(P, D) * (D ** -0.5)
        B_im = (lambda *s: torch.randn(*s, dtype=torch.bfloat16) * 0.8)(P, D) * (D ** -0.5)
        C_re = (lambda *s: torch.randn(*s, dtype=torch.bfloat16) * 0.8)(D, P) * (P ** -0.5)
        C_im = (lambda *s: torch.randn(*s, dtype=torch.bfloat16) * 0.8)(D, P) * (P ** -0.5)
        log_dt = (lambda *s: torch.randn(*s, dtype=torch.bfloat16) * 0.4)(P) * 0.3 - 2.0
        Dskip = (lambda *s: torch.randn(*s, dtype=torch.bfloat16) * 0.1)(D)
        return {
            "x": _w((lambda *s: torch.randn(*s, dtype=torch.bfloat16) * 0.05)(B, S, D)),
            "Lambda_re": _w(Lambda_re),
            "Lambda_im": _w(Lambda_im),
            "B_re": _w(B_re),
            "B_im": _w(B_im),
            "C_re": _w(C_re),
            "C_im": _w(C_im),
            "log_dt": _w(log_dt),
            "Dskip": _w(Dskip),
        }
    _A_in = _A_setup()

    def _B_setup():
        B, S, D, F = 1, 2048, 512, 1376
        return {
            "x": _w((lambda *s: torch.randn(*s, dtype=torch.bfloat16) * 0.05)(B, S, D)),
            "w1": _w((lambda *s: torch.randn(*s, dtype=torch.bfloat16) * 0.8)(D, F) * (D ** -0.5)),
            "b1": _w((lambda *s: torch.randn(*s, dtype=torch.bfloat16) * 0.4)(F)),
            "w2": _w((lambda *s: torch.randn(*s, dtype=torch.bfloat16) * 0.05)(F, D) * (F ** -0.5)),
            "b2": _w((lambda *s: torch.randn(*s, dtype=torch.bfloat16) * 0.05)(D)),
        }
    _B_in = _B_setup()

    return {
        "A_x": _A_in["x"],
        "A_Lambda_re": _A_in["Lambda_re"],
        "A_Lambda_im": _A_in["Lambda_im"],
        "A_B_re": _A_in["B_re"],
        "A_B_im": _A_in["B_im"],
        "A_C_re": _A_in["C_re"],
        "A_C_im": _A_in["C_im"],
        "A_log_dt": _A_in["log_dt"],
        "A_Dskip": _A_in["Dskip"],
        "B_x": _B_in["x"],
        "B_w1": _B_in["w1"],
        "B_b1": _B_in["b1"],
        "B_w2": _B_in["w2"],
        "B_b2": _B_in["b2"],
        "gate_w": _w((lambda *s: torch.randn(*s, dtype=torch.bfloat16) * 0.05)(512) * 16.0),
    }

def reference(A_x, A_Lambda_re, A_Lambda_im, A_B_re, A_B_im, A_C_re, A_C_im, A_log_dt, A_Dskip, B_x, B_w1, B_b1, B_w2, B_b2, gate_w):
    def _A_ref(x, Lambda_re, Lambda_im, B_re, B_im, C_re, C_im, log_dt, Dskip):
        Bsz, L, H = x.shape
        Lam = Lambda_re + 1j * Lambda_im
        Bmat = B_re + 1j * B_im
        Cmat = C_re + 1j * C_im
        dt = torch.exp(log_dt)
        Lam_bar = torch.exp(dt * Lam)
        B_bar = ((Lam_bar - 1.0) / Lam)[:, None] * Bmat
        Bu = torch.einsum("bld,pd->blp", x + 0j, B_bar)
        h = torch.zeros_like(Bu[:, 0, :])
        hs = []
        for t in range(L):
            h = Lam_bar[None, :] * h + Bu[:, t, :]
            hs.append(h)
        hseq = torch.stack(hs, 1)
        y = 2.0 * torch.einsum("blp,dp->bld", hseq, Cmat).real + x * Dskip[None, None, :]
        return y

    def _B_ref(x, w1, b1, w2, b2):
        y = _layernorm(x, axis=-1)
        h = _gelu(torch.einsum("bsd,df->bsf", y, w1) + b1)
        return torch.einsum("bsf,fd->bsd", h, w2) + b2

    x = A_x
    g = _sigmoid((x * gate_w).sum(-1, keepdims=True))
    a = _A_ref(x, A_Lambda_re, A_Lambda_im, A_B_re, A_B_im, A_C_re, A_C_im, A_log_dt, A_Dskip)
    b = _B_ref(x, B_w1, B_b1, B_w2, B_b2)
    return g * a + (1 - g) * b
```

```asm
; @launch grid=(256,1,1) block=(512,1,1) lds=163840
.amdgcn_target "amdgcn-amd-amdhsa--gfx950"
.text
.globl gated_mix__ssm_conv_s5__mixer_channel_mlp__prompt_kernel
.p2align 8
.type gated_mix__ssm_conv_s5__mixer_channel_mlp__prompt_kernel,@function
gated_mix__ssm_conv_s5__mixer_channel_mlp__prompt_kernel:
    s_cmp_ge_u32 s2, 256
    s_cbranch_scc1 L_EXIT
    s_load_dwordx16 s[16:31], s[0:1], 0
    s_load_dwordx16 s[32:47], s[0:1], 64
    s_load_dwordx4 s[48:51], s[0:1], 128
    v_lshrrev_b32 v1, 6, v0
    v_and_b32 v0, 63, v0
    s_lshr_b32 s14, s2, 3
    v_readfirstlane_b32 s3, v1
    s_and_b32 s5, s14, 7
    s_and_b32 s13, s2, 1
    s_lshl_b32 s13, s13, 3
    s_add_u32 s5, s5, s13
    s_lshr_b32 s14, s14, 3
    s_and_b32 s13, s2, 6
    s_lshl_b32 s13, s13, 1
    s_add_u32 s4, s13, s14
    s_and_b32 s6, s3, 3
    s_cmp_ge_u32 s3, 4
    s_cbranch_scc1 L_LOADER
    s_branch L_COMPUTE
L_LOADER:
    s_and_b32 s14, s5, 3
    s_lshr_b32 s13, s5, 2
    s_mul_i32 s13, s13, 11
    s_mul_i32 s9, s14, 3
    s_add_u32 s9, s9, s13
    s_min_u32 s9, s9, 41
    s_cmp_eq_u32 s14, 3
    s_cselect_b32 s10, 2, 3
    s_cmp_eq_u32 s5, 14
    s_cselect_b32 s10, 2, s10
    v_lshrrev_b32 v141, 3, v0
    v_and_b32 v142, 7, v0
    v_lshrrev_b32 v143, 1, v141
    v_xor_b32 v143, v143, v142
    v_lshlrev_b32 v143, 4, v143
    v_lshrrev_b32 v24, 2, v141
    v_lshlrev_b32 v24, 4, v24
    v_and_b32 v25, 1, v141
    v_lshl_add_u32 v24, v25, 3, v24
    v_bfe_u32 v6, v141, 1, 1
    v_add_u32 v24, v24, v6
    v_lshl_add_u32 v24, v24, 10, v143
    v_xor_b32 v25, 64, v24
    v_add_u32 v26, 0x800, v24
    v_add_u32 v27, 0xc00, v25
    v_add_u32 v25, 0x400, v25
    v_lshl_add_u32 v4, v141, 10, v143
    v_xor_b32 v5, 64, v4
    v_add_u32 v5, 7168, v5
    v_lshrrev_b32 v8, 2, v0
    v_mul_u32_u24 v8, 2752, v8
    v_and_b32 v143, 3, v0
    v_lshl_add_u32 v8, v143, 4, v8
    s_and_b32 s83, s2, 6
    s_lshl_b32 s14, s2, 2
    s_add_u32 s83, s83, s14
    s_and_b32 s83, s83, 7
    s_lshl_b32 s14, s83, 7
    s_lshl_b32 s84, s4, 2
    s_add_u32 s84, s84, s6
    s_lshl_b32 s84, s84, 15
    s_add_u32 s84, s84, s14
    s_mul_i32 s87, s6, 7168
    s_lshl_b32 s85, s5, 1
    s_and_b32 s13, s6, 1
    s_add_u32 s85, s85, s13
    s_lshl_b32 s85, s85, 14
    s_add_u32 s85, s85, s14
    s_lshl_b32 s86, s83, 2
    s_add_u32 s86, s86, s6
    s_mul_i32 s86, s86, 44032
    s_lshl_b32 s82, s9, 6
    s_add_u32 s86, s86, s82
    s_waitcnt lgkmcnt(0)
    s_mov_b32 s52, s16
    s_mov_b32 s53, s17
    s_mov_b32 s54, 2097152
    s_mov_b32 s55, 0x20000
    s_add_u32 m0, s87, 0
    s_nop 0
    buffer_load_dwordx4 v24, s[52:55], s84 offen offset:0  lds
    buffer_load_dwordx4 v25, s[52:55], s84 offen offset:1024  lds
    buffer_load_dwordx4 v26, s[52:55], s84 offen offset:2048  lds
    buffer_load_dwordx4 v27, s[52:55], s84 offen offset:3072  lds
    s_cmp_ge_u32 s6, 2
    s_cselect_b32 s56, s24, s22
    s_cselect_b32 s57, s25, s23
    s_mov_b32 s58, 524288
    s_mov_b32 s59, 0x20000
    s_add_u32 m0, s87, 4096
    s_nop 0
    buffer_load_dwordx4 v4, s[56:59], s85 offen offset:0  lds
    buffer_load_dwordx4 v5, s[56:59], s85 offen offset:1024  lds
    s_mov_b32 s60, s36
    s_mov_b32 s61, s37
    s_mov_b32 s62, 1409024
    s_mov_b32 s63, 0x20000
    s_add_u32 m0, s87, 6144
    s_nop 0
    buffer_load_dwordx4 v8, s[60:63], s86 offen offset:0  lds
    s_add_u32 m0, s87, 28672
    s_add_u32 s83, s83, 1
    s_cmp_eq_u32 s83, 8
    s_cselect_b32 s14, -7, 1
    s_lshl_b32 s15, s14, 7
    s_mul_i32 s14, s14, 176128
    s_add_u32 s84, s84, s15
    s_add_u32 s85, s85, s15
    s_add_u32 s86, s86, s14
    buffer_load_dwordx4 v24, s[52:55], s84 offen offset:0  lds
    buffer_load_dwordx4 v25, s[52:55], s84 offen offset:1024  lds
    s_bfe_u32 s7, s5, 0x10002
    s_lshr_b32 s8, s5, 3
    s_lshl_b32 s8, s8, 2
    s_and_b32 s14, s5, 3
    s_add_u32 s8, s8, s14
    v_and_b32 v1, 31, v0
    v_lshrrev_b32 v2, 5, v0
    s_and_b32 s13, s2, 6
    s_lshl_b32 s14, s2, 2
    s_add_u32 s13, s13, s14
    s_and_b32 s13, s13, 7
    s_lshl_b32 s14, s6, 1
    s_add_u32 s13, s13, s14
    s_and_b32 s88, s13, 7
    s_add_u32 s13, s13, 1
    s_and_b32 s89, s13, 7
    s_mul_i32 s88, s88, 176128
    s_mul_i32 s89, s89, 176128
    s_add_u32 s88, s88, s82
    s_add_u32 s89, s89, s82
    s_cmp_eq_u32 s10, 3
    s_cselect_b32 s82, 64, 2146435072
    v_add_u32 v9, s82, v8
    v_lshlrev_b32 v6, 2, v6
    v_xor_b32 v6, v6, v142
    v_lshlrev_b32 v6, 4, v6
    v_lshl_add_u32 v6, v141, 10, v6
    v_add_u32 v7, 7168, v6
    v_bfe_u32 v136, v0, 2, 2
    v_bfe_u32 v138, v0, 4, 1
    v_and_b32 v139, 3, v0
    v_lshlrev_b32 v139, 3, v139
    v_lshl_add_u32 v139, v138, 5, v139
    s_lshl_b32 s90, s6, 13
    v_lshl_add_u32 v246, v2, 3, v136
    v_lshl_add_u32 v246, v246, 6, v139
    v_add_u32 v247, s90, v246
    v_add_u32 v246, s87, v246
    v_mov_b32 v244, 0x3f803f80
    v_mov_b32 v245, 0x3f803f80
    s_mov_b32 s76, s50
    s_mov_b32 s77, s51
    s_mov_b32 s78, 10944512
    s_mov_b32 s79, 0x20000
    s_mov_b32 s64, s40
    s_mov_b32 s65, s41
    s_mov_b32 s66, 1409024
    s_mov_b32 s67, 0x20000
    s_mov_b32 s68, s26
    s_mov_b32 s69, s27
    s_mov_b32 s70, 524288
    s_mov_b32 s71, 0x20000
    s_mov_b32 s72, s28
    s_mov_b32 s73, s29
    s_mov_b32 s74, 524288
    s_mov_b32 s75, 0x20000
    v_lshl_add_u32 v137, v2, 2, v136
    v_lshl_add_u32 v137, v137, 7, v139
    v_lshrrev_b32 v136, 1, v136
    v_lshl_add_u32 v137, v136, 6, v137
    v_xor_b32 v138, 64, v137
    v_add_u32 v12, s90, v137
    v_add_u32 v13, s90, v138
    v_add_u32 v14, 0x10000, v12
    v_add_u32 v15, 0x10000, v13
    v_bfe_u32 v136, v1, 1, 3
    v_lshl_add_u32 v137, v1, 7, s90
    v_add_u32 v138, 0, v2
    v_xor_b32 v138, v138, v136
    v_lshl_add_u32 v16, v138, 4, v137
    v_add_u32 v20, 0x10000, v16
    v_add_u32 v138, 2, v2
    v_xor_b32 v138, v138, v136
    v_lshl_add_u32 v17, v138, 4, v137
    v_add_u32 v21, 0x10000, v17
    v_add_u32 v138, 4, v2
    v_xor_b32 v138, v138, v136
    v_lshl_add_u32 v18, v138, 4, v137
    v_add_u32 v22, 0x10000, v18
    v_add_u32 v138, 6, v2
    v_xor_b32 v138, v138, v136
    v_lshl_add_u32 v19, v138, 4, v137
    v_add_u32 v23, 0x10000, v19
    v_lshlrev_b32 v11, 4, v0
    s_mul_i32 s14, s4, 614400
    s_lshl_b32 s13, s7, 11
    s_add_u32 s14, s14, s13
    s_lshl_b32 s15, s8, 7
    s_mul_i32 s13, s6, 11
    s_add_u32 s13, s13, 0
    s_lshl_b32 s91, s13, 15
    s_add_u32 s91, s91, s15
    s_lshl_b32 s95, s13, 13
    s_add_u32 s95, s95, s14
    s_mul_i32 s13, s6, 11
    s_add_u32 s13, s13, 3
    s_lshl_b32 s92, s13, 15
    s_add_u32 s92, s92, s15
    s_lshl_b32 s96, s13, 13
    s_add_u32 s96, s96, s14
    s_mul_i32 s13, s6, 11
    s_add_u32 s13, s13, 6
    s_lshl_b32 s93, s13, 15
    s_add_u32 s93, s93, s15
    s_lshl_b32 s97, s13, 13
    s_add_u32 s97, s97, s14
    s_mul_i32 s13, s6, 11
    s_add_u32 s13, s13, 9
    s_min_u32 s13, s13, 41
    s_lshl_b32 s94, s13, 15
    s_add_u32 s94, s94, s15
    s_lshl_b32 s98, s13, 13
    s_add_u32 s98, s98, s14
    s_cmp_eq_u32 s6, 3
    s_cselect_b32 s99, 2146435072, s93
    s_lshr_b32 s13, s2, 3
    s_lshl_b32 s13, s13, 2
    s_add_u32 s13, s13, s6
    s_mul_i32 s13, s13, 19
    v_min_u32 v144, 18, v0
    v_add_u32 v144, s13, v144
    v_min_u32 v144, 2399, v144
    s_and_b32 s14, s2, 1
    s_lshl_b32 s15, s14, 9
    v_lshrrev_b32 v145, 2, v144
    v_and_b32 v146, 3, v144
    v_lshlrev_b32 v145, 10, v145
    v_lshl_add_u32 v145, v146, 7, v145
    v_add_u32 v145, s15, v145
    v_subrev_u32 v146, 1376, v144
    v_and_b32 v146, 511, v146
    s_lshl_b32 s15, s14, 18
    v_lshl_add_u32 v146, v146, 7, s15
    v_cmp_gt_u32 vcc, 1888, v144
    v_mov_b32 v147, s28
    v_mov_b32 v148, s29
    v_mov_b32 v28, s26
    v_mov_b32 v29, s27
    v_cndmask_b32 v147, v147, v28, vcc
    v_cndmask_b32 v148, v148, v29, vcc
    v_cmp_gt_u32 vcc, 1376, v144
    v_mov_b32 v28, s40
    v_mov_b32 v29, s41
    v_cndmask_b32 v28, v147, v28, vcc
    v_cndmask_b32 v29, v148, v29, vcc
    v_cndmask_b32 v145, v146, v145, vcc
    v_mov_b32 v146, 0x10000
    v_mov_b32 v32, 352256
    v_cndmask_b32 v32, v146, v32, vcc
    s_lshr_b32 s13, s2, 3
    s_lshl_b32 s13, s13, 2
    s_add_u32 s13, s13, s6
    s_mul_i32 s13, s13, 2752
    s_mul_i32 s15, s14, 1280
    s_add_u32 s13, s13, s15
    v_subrev_u32 v146, 19, v0
    v_min_u32 v146, 11, v146
    v_lshl_add_u32 v146, v146, 7, s13
    v_cmp_lt_u32 vcc, 18, v0
    v_mov_b32 v147, s36
    v_mov_b32 v148, s37
    v_mov_b32 v144, 352256
    v_cndmask_b32 v28, v28, v147, vcc
    v_cndmask_b32 v29, v29, v148, vcc
    v_cndmask_b32 v145, v145, v146, vcc
    v_cndmask_b32 v32, v32, v144, vcc
    v_add_co_u32 v28, vcc, v28, v145
    s_bfe_u32 s16, s2, 0x20001
    s_nop 0
    v_addc_co_u32 v29, vcc, 0, v29, vcc
    buffer_load_dwordx4 v26, s[52:55], s84 offen offset:2048  lds
    buffer_load_dwordx4 v27, s[52:55], s84 offen offset:3072  lds
    s_add_u32 m0, s87, 32768
    s_nop 0
    buffer_load_dwordx4 v4, s[56:59], s85 offen offset:0  lds
    buffer_load_dwordx4 v5, s[56:59], s85 offen offset:1024  lds
    s_add_u32 m0, s87, 34816
    s_nop 0
    buffer_load_dwordx4 v8, s[60:63], s86 offen offset:0  lds
    s_add_u32 m0, s87, 57344
    s_add_u32 s83, s83, 1
    s_cmp_eq_u32 s83, 8
    s_cselect_b32 s14, -7, 1
    s_lshl_b32 s15, s14, 7
    s_mul_i32 s14, s14, 176128
    s_add_u32 s84, s84, s15
    s_add_u32 s85, s85, s15
    s_add_u32 s86, s86, s14
    buffer_load_dwordx4 v24, s[52:55], s84 offen offset:0  lds
    buffer_load_dwordx4 v25, s[52:55], s84 offen offset:1024  lds
    buffer_load_dwordx4 v26, s[52:55], s84 offen offset:2048  lds
    buffer_load_dwordx4 v27, s[52:55], s84 offen offset:3072  lds
    s_waitcnt vmcnt(11)
    ds_read_b64_tr_b16 v[168:169], v246 offset:6144
    ds_read_b64_tr_b16 v[170:171], v246 offset:6400
    s_barrier
    s_cmp_lg_u32 s6, 3
    s_cbranch_scc1 L_L_P0
    s_lshl_b32 s14, s5, 6
    v_lshl_add_u32 v136, v1, 1, s14
    s_lshl_b32 s14, s10, 4
    s_sub_u32 s14, s14, 1
    v_min_u32 v137, s14, v0
    s_lshl_b32 s14, s9, 6
    v_lshl_add_u32 v137, v137, 2, s14
    global_load_ushort v140, v136, s[18:19]
    global_load_ushort v141, v136, s[20:21]
    global_load_ushort v142, v136, s[30:31]
    global_load_dword v143, v137, s[38:39]
    s_lshl_b32 s14, s8, 7
    v_lshl_add_u32 v138, v1, 2, s14
    global_load_dword v158, v138, s[32:33]
    global_load_dword v159, v138, s[42:43]
L_L_P0:
    s_add_u32 m0, s87, 61440
    s_nop 0
    buffer_load_dwordx4 v4, s[56:59], s85 offen offset:0  lds
    buffer_load_dwordx4 v5, s[56:59], s85 offen offset:1024  lds
    s_add_u32 m0, s87, 63488
    s_nop 0
    buffer_load_dwordx4 v8, s[60:63], s86 offen offset:0  lds
    s_add_u32 m0, s87, 86016
    s_add_u32 s83, s83, 1
    s_cmp_eq_u32 s83, 8
    s_cselect_b32 s14, -7, 1
    s_lshl_b32 s15, s14, 7
    s_mul_i32 s14, s14, 176128
    s_add_u32 s84, s84, s15
    s_add_u32 s85, s85, s15
    s_add_u32 s86, s86, s14
    buffer_load_dwordx4 v24, s[52:55], s84 offen offset:0  lds
    buffer_load_dwordx4 v25, s[52:55], s84 offen offset:1024  lds
    buffer_load_dwordx4 v26, s[52:55], s84 offen offset:2048  lds
    buffer_load_dwordx4 v27, s[52:55], s84 offen offset:3072  lds
    s_waitcnt lgkmcnt(0)
    v_mfma_f32_4x4x4_16b_bf16 v[212:215], v[244:245], v[168:169], 0
    v_mfma_f32_4x4x4_16b_bf16 v[216:219], v[244:245], v[170:171], 0
    s_waitcnt vmcnt(11)
    ds_read_b64_tr_b16 v[168:169], v246 offset:34816
    ds_read_b64_tr_b16 v[170:171], v246 offset:35072
    s_barrier
    s_add_u32 m0, s87, 90112
    s_nop 0
    buffer_load_dwordx4 v4, s[56:59], s85 offen offset:0  lds
    buffer_load_dwordx4 v5, s[56:59], s85 offen offset:1024  lds
    s_add_u32 m0, s87, 92160
    s_nop 0
    buffer_load_dwordx4 v8, s[60:63], s86 offen offset:0  lds
    s_bfe_u32 s14, s2, 0x20003
    s_cmp_lg_u32 s14, 0
    s_cbranch_scc1 L_L_TG0
    v_mad_u64_u32 v[30:31], vcc, v32, s16, v[28:29]
    s_add_u32 s16, s16, 1
    s_and_b32 s16, s16, 3
    global_load_dword v248, v[30:31], off
L_L_TG0:
    s_add_u32 m0, s87, 0
    s_add_u32 s83, s83, 1
    s_cmp_eq_u32 s83, 8
    s_cselect_b32 s14, -7, 1
    s_lshl_b32 s15, s14, 7
    s_mul_i32 s14, s14, 176128
    s_add_u32 s84, s84, s15
    s_add_u32 s85, s85, s15
    s_add_u32 s86, s86, s14
    buffer_load_dwordx4 v24, s[52:55], s84 offen offset:0  lds
    buffer_load_dwordx4 v25, s[52:55], s84 offen offset:1024  lds
    buffer_load_dwordx4 v26, s[52:55], s84 offen offset:2048  lds
    buffer_load_dwordx4 v27, s[52:55], s84 offen offset:3072  lds
    s_waitcnt lgkmcnt(0)
    v_mfma_f32_4x4x4_16b_bf16 v[212:215], v[244:245], v[168:169], v[212:215]
    v_mfma_f32_4x4x4_16b_bf16 v[216:219], v[244:245], v[170:171], v[216:219]
    s_waitcnt vmcnt(11)
    v_add_u32 v246, 57344, v246
    ds_read_b64_tr_b16 v[168:169], v246 offset:6144
    ds_read_b64_tr_b16 v[170:171], v246 offset:6400
    s_barrier
    s_add_u32 m0, s87, 4096
    s_nop 0
    buffer_load_dwordx4 v4, s[56:59], s85 offen offset:0  lds
    buffer_load_dwordx4 v5, s[56:59], s85 offen offset:1024  lds
    s_add_u32 m0, s87, 6144
    s_nop 0
    buffer_load_dwordx4 v8, s[60:63], s86 offen offset:0  lds
    s_bfe_u32 s14, s2, 0x20003
    s_cmp_lg_u32 s14, 1
    s_cbranch_scc1 L_L_TG1
    v_mad_u64_u32 v[30:31], vcc, v32, s16, v[28:29]
    s_add_u32 s16, s16, 1
    s_and_b32 s16, s16, 3
    global_load_dword v248, v[30:31], off
L_L_TG1:
    s_add_u32 m0, s87, 28672
    s_add_u32 s83, s83, 1
    s_cmp_eq_u32 s83, 8
    s_cselect_b32 s14, -7, 1
    s_lshl_b32 s15, s14, 7
    s_mul_i32 s14, s14, 176128
    s_add_u32 s84, s84, s15
    s_add_u32 s85, s85, s15
    s_add_u32 s86, s86, s14
    buffer_load_dwordx4 v24, s[52:55], s84 offen offset:0  lds
    buffer_load_dwordx4 v25, s[52:55], s84 offen offset:1024  lds
    buffer_load_dwordx4 v26, s[52:55], s84 offen offset:2048  lds
    buffer_load_dwordx4 v27, s[52:55], s84 offen offset:3072  lds
    s_waitcnt lgkmcnt(0)
    v_mfma_f32_4x4x4_16b_bf16 v[212:215], v[244:245], v[168:169], v[212:215]
    v_mfma_f32_4x4x4_16b_bf16 v[216:219], v[244:245], v[170:171], v[216:219]
    s_waitcnt vmcnt(11)
    ds_read_b64_tr_b16 v[168:169], v246 offset:34816
    ds_read_b64_tr_b16 v[170:171], v246 offset:35072
    s_barrier
    s_add_u32 m0, s87, 32768
    s_nop 0
    buffer_load_dwordx4 v4, s[56:59], s85 offen offset:0  lds
    buffer_load_dwordx4 v5, s[56:59], s85 offen offset:1024  lds
    s_add_u32 m0, s87, 34816
    s_nop 0
    buffer_load_dwordx4 v8, s[60:63], s86 offen offset:0  lds
    s_bfe_u32 s14, s2, 0x20003
    s_cmp_lg_u32 s14, 2
    s_cbranch_scc1 L_L_TG2
    v_mad_u64_u32 v[30:31], vcc, v32, s16, v[28:29]
    s_add_u32 s16, s16, 1
    s_and_b32 s16, s16, 3
    global_load_dword v248, v[30:31], off
L_L_TG2:
    s_add_u32 m0, s87, 57344
    s_add_u32 s83, s83, 1
    s_cmp_eq_u32 s83, 8
    s_cselect_b32 s14, -7, 1
    s_lshl_b32 s15, s14, 7
    s_mul_i32 s14, s14, 176128
    s_add_u32 s84, s84, s15
    s_add_u32 s85, s85, s15
    s_add_u32 s86, s86, s14
    buffer_load_dwordx4 v24, s[52:55], s84 offen offset:0  lds
    buffer_load_dwordx4 v25, s[52:55], s84 offen offset:1024  lds
    buffer_load_dwordx4 v26, s[52:55], s84 offen offset:2048  lds
    buffer_load_dwordx4 v27, s[52:55], s84 offen offset:3072  lds
    s_waitcnt lgkmcnt(0)
    v_mfma_f32_4x4x4_16b_bf16 v[212:215], v[244:245], v[168:169], v[212:215]
    v_mfma_f32_4x4x4_16b_bf16 v[216:219], v[244:245], v[170:171], v[216:219]
    s_cmp_lg_u32 s6, 3
    s_cbranch_scc1 L_L_P3
    v_lshlrev_b32 v142, 16, v142
    v_lshlrev_b32 v140, 16, v140
    v_mul_f32 v142, 0x3fb8aa3b, v142
    v_lshlrev_b32 v141, 16, v141
    v_exp_f32 v142, v142
    s_nop 0
    v_cvt_pk_bf16_f32 v142, v142, v142
    v_and_b32 v142, 0xffff0000, v142
    v_mul_f32 v144, v142, v140
    v_mul_f32 v145, v142, v141
    v_mul_f32 v144, 0x3fb8aa3b, v144
    v_mul_f32 v145, 0.15915494, v145
    v_exp_f32 v144, v144
    v_fract_f32 v145, v145
    s_nop 0
    v_cos_f32 v146, v145
    v_sin_f32 v147, v145
    s_nop 0
    v_mul_f32 v152, v144, v146
    v_mul_f32 v153, v144, v147
    v_mul_f32 v148, v140, v140
    v_add_f32 v144, -1.0, v152
    v_fmac_f32 v148, v141, v141
    v_mul_f32 v145, v144, v140
    v_rcp_f32 v148, v148
    v_mul_f32 v146, v153, v140
    v_fmac_f32 v145, v153, v141
    v_fma_f32 v146, -v144, v141, v146
    v_mul_f32 v154, v145, v148
    v_mul_f32 v155, v146, v148
    v_mul_f32 v144, v153, v153
    v_mul_f32 v145, v152, v153
    v_fma_f32 v200, v152, v152, -v144
    v_add_f32 v201, v145, v145
    v_mul_f32 v144, v201, v201
    v_mul_f32 v145, v200, v201
    v_fma_f32 v156, v200, v200, -v144
    v_add_f32 v157, v145, v145
    v_mul_f32 v144, v157, v157
    v_mul_f32 v145, v156, v157
    v_fma_f32 v200, v156, v156, -v144
    v_add_f32 v201, v145, v145
    v_lshlrev_b32 v136, 3, v1
    v_add_u32 v136, 153600, v136
    ds_write_b64 v136, v[152:153]
    ds_write_b64 v136, v[154:155] offset:2560
    ds_write_b64 v136, v[200:201] offset:5120
    v_lshlrev_b32 v144, 16, v143
    v_and_b32 v145, 0xffff0000, v143
    v_min_u32 v136, 47, v0
    v_lshlrev_b32 v136, 3, v136
    v_add_u32 v136, 151936, v136
    s_mov_b32 exec_hi, 0xffff
    ds_write_b64 v136, v[144:145]
    s_mov_b64 exec, -1
    v_lshlrev_b32 v136, 2, v1
    v_add_u32 v136, 163424, v136
    ds_write_b32 v136, v158
    ds_write_b32 v136, v159 offset:128
L_L_P3:
    s_waitcnt vmcnt(11)
    v_add_u32 v246, 4294909952, v246
    ds_read_b64_tr_b16 v[168:169], v246 offset:6144
    ds_read_b64_tr_b16 v[170:171], v246 offset:6400
    s_barrier
    s_lshl_b32 s14, s4, 2
    s_add_u32 s14, s14, s6
    s_lshl_b32 s14, s14, 9
    s_add_u32 s14, s14, 10485760
    s_mul_i32 s15, s6, 2560
    s_add_u32 m0, s15, 153088
    s_mov_b32 exec_hi, 0
    buffer_load_dwordx4 v11, s[76:79], s14 offen sc1 lds
    s_mov_b64 exec, -1
    s_add_u32 m0, s87, 61440
    s_nop 0
    buffer_load_dwordx4 v4, s[56:59], s85 offen offset:0  lds
    buffer_load_dwordx4 v5, s[56:59], s85 offen offset:1024  lds
    s_add_u32 m0, s87, 63488
    s_nop 0
    buffer_load_dwordx4 v8, s[60:63], s86 offen offset:0  lds
    s_bfe_u32 s14, s2, 0x20003
    s_cmp_lg_u32 s14, 3
    s_cbranch_scc1 L_L_TG3
    v_mad_u64_u32 v[30:31], vcc, v32, s16, v[28:29]
    s_add_u32 s16, s16, 1
    s_and_b32 s16, s16, 3
    global_load_dword v248, v[30:31], off
L_L_TG3:
    s_add_u32 m0, s87, 86016
    s_add_u32 s83, s83, 1
    s_cmp_eq_u32 s83, 8
    s_cselect_b32 s14, -7, 1
    s_lshl_b32 s15, s14, 7
    s_mul_i32 s14, s14, 176128
    s_add_u32 s84, s84, s15
    s_add_u32 s85, s85, s15
    s_add_u32 s86, s86, s14
    buffer_load_dwordx4 v24, s[52:55], s84 offen offset:0  lds
    buffer_load_dwordx4 v25, s[52:55], s84 offen offset:1024  lds
    buffer_load_dwordx4 v26, s[52:55], s84 offen offset:2048  lds
    s_waitcnt lgkmcnt(0)
    v_mfma_f32_4x4x4_16b_bf16 v[212:215], v[244:245], v[168:169], v[212:215]
    v_mfma_f32_4x4x4_16b_bf16 v[216:219], v[244:245], v[170:171], v[216:219]
    s_cmp_lg_u32 s6, 3
    s_cbranch_scc1 L_L_P4
    v_mul_f32 v144, v201, v201
    v_mul_f32 v145, v200, v201
    v_fma_f32 v204, v200, v200, -v144
    v_add_f32 v205, v145, v145
    v_mul_f32 v144, v205, v205
    v_mul_f32 v145, v204, v205
    v_fma_f32 v156, v204, v204, -v144
    v_add_f32 v157, v145, v145
    v_mul_f32 v144, v157, v157
    v_mul_f32 v145, v156, v157
    v_fma_f32 v232, v156, v156, -v144
    v_add_f32 v233, v145, v145
    v_mul_f32 v144, v233, v233
    v_mul_f32 v145, v232, v233
    v_fma_f32 v204, v232, v232, -v144
    v_add_f32 v205, v145, v145
    v_mul_f32 v144, v205, v205
    v_mul_f32 v145, v204, v205
    v_fma_f32 v208, v204, v204, -v144
    v_add_f32 v209, v145, v145
    v_mul_f32 v144, v209, v209
    v_mul_f32 v145, v208, v209
    v_fma_f32 v156, v208, v208, -v144
    v_add_f32 v157, v145, v145
    v_mul_f32 v144, v157, v157
    v_mul_f32 v145, v156, v157
    v_fma_f32 v208, v156, v156, -v144
    v_add_f32 v209, v145, v145
    v_sub_f32 v202, 0, v201
    v_mov_b32 v203, v201
    v_sub_f32 v206, 0, v205
    v_mov_b32 v207, v205
    v_sub_f32 v210, 0, v209
    v_mov_b32 v211, v209
    v_sub_f32 v234, 0, v233
    v_mov_b32 v235, v233
L_L_P4:
    s_waitcnt vmcnt(11)
    ds_read_b64_tr_b16 v[168:169], v246 offset:34816
    ds_read_b64_tr_b16 v[170:171], v246 offset:35072
    s_barrier
    v_mov_b32 v160, 163328
    ds_read_b64 v[162:163], v160 offset:8
    buffer_load_dwordx4 v27, s[52:55], s84 offen offset:3072  lds
    s_add_u32 m0, s87, 90112
    s_nop 0
    buffer_load_dwordx4 v4, s[56:59], s85 offen offset:0  lds
    buffer_load_dwordx4 v5, s[56:59], s85 offen offset:1024  lds
    s_add_u32 m0, s87, 92160
    s_nop 0
    buffer_load_dwordx4 v8, s[60:63], s86 offen offset:0  lds
    s_waitcnt lgkmcnt(0)
    v_mfma_f32_4x4x4_16b_bf16 v[212:215], v[244:245], v[168:169], v[212:215]
    v_mfma_f32_4x4x4_16b_bf16 v[216:219], v[244:245], v[170:171], v[216:219]
    v_readfirstlane_b32 s11, v162
    v_readfirstlane_b32 s12, v163
    s_waitcnt vmcnt(7)
    v_add_u32 v246, 57344, v246
    ds_read_b64_tr_b16 v[168:169], v246 offset:6144
    ds_read_b64_tr_b16 v[170:171], v246 offset:6400
    s_barrier
    s_add_u32 m0, s90, 114688
    s_add_u32 s17, s88, 64
    buffer_load_dwordx4 v8, s[60:63], s17 offen offset:0  lds
    s_add_u32 m0, s90, 0
    s_nop 0
    buffer_load_dwordx4 v9, s[60:63], s17 offen offset:0  lds
    s_add_u32 m0, s90, 115712
    s_add_u32 s17, s88, 44096
    buffer_load_dwordx4 v8, s[60:63], s17 offen offset:0  lds
    s_add_u32 m0, s90, 1024
    s_nop 0
    buffer_load_dwordx4 v9, s[60:63], s17 offen offset:0  lds
    s_add_u32 m0, s90, 116736
    s_add_u32 s17, s88, 88128
    buffer_load_dwordx4 v8, s[60:63], s17 offen offset:0  lds
    s_add_u32 m0, s90, 2048
    s_nop 0
    buffer_load_dwordx4 v9, s[60:63], s17 offen offset:0  lds
    s_add_u32 m0, s90, 117760
    s_add_u32 s17, s88, 132160
    buffer_load_dwordx4 v8, s[60:63], s17 offen offset:0  lds
    s_add_u32 m0, s90, 3072
    s_nop 0
    buffer_load_dwordx4 v9, s[60:63], s17 offen offset:0  lds
    s_add_u32 m0, s90, 118784
    s_add_u32 s17, s89, 64
    buffer_load_dwordx4 v8, s[60:63], s17 offen offset:0  lds
    s_add_u32 m0, s90, 4096
    s_nop 0
    buffer_load_dwordx4 v9, s[60:63], s17 offen offset:0  lds
    s_add_u32 m0, s90, 119808
    s_add_u32 s17, s89, 44096
    buffer_load_dwordx4 v8, s[60:63], s17 offen offset:0  lds
    s_waitcnt lgkmcnt(0)
    v_mfma_f32_4x4x4_16b_bf16 v[212:215], v[244:245], v[168:169], v[212:215]
    v_mfma_f32_4x4x4_16b_bf16 v[216:219], v[244:245], v[170:171], v[216:219]
    s_waitcnt vmcnt(11)
    ds_read_b64_tr_b16 v[168:169], v246 offset:34816
    ds_read_b64_tr_b16 v[170:171], v246 offset:35072
    s_waitcnt lgkmcnt(0)
    v_mfma_f32_4x4x4_16b_bf16 v[212:215], v[244:245], v[168:169], v[212:215]
    v_mfma_f32_4x4x4_16b_bf16 v[216:219], v[244:245], v[170:171], v[216:219]
    s_nop 0
    s_lshl_b32 s14, s6, 7
    s_add_u32 s14, s14, 152320
    v_lshl_add_u32 v168, v1, 2, s14
    s_nop 1
    v_add_f32 v212, v212, v216
    v_mov_b32 v213, v212
    s_nop 1
    v_permlane32_swap_b32 v212, v213
    v_add_f32 v212, v212, v213
    ds_write_b32 v168, v212
    s_waitcnt lgkmcnt(0)
    s_barrier
    s_cmp_lg_u32 s6, 0
    s_cbranch_scc1 L_L_RD0
    v_lshlrev_b32 v168, 2, v1
    v_add_u32 v169, 152320, v168
    v_add_u32 v168, 151552, v168
    ds_read_b32 v212, v169 offset:0
    ds_read_b32 v213, v169 offset:128
    ds_read_b32 v214, v169 offset:256
    ds_read_b32 v215, v169 offset:384
    s_waitcnt lgkmcnt(0)
    v_add_f32 v212, v212, v213
    v_add_f32 v214, v214, v215
    v_add_f32 v212, v212, v214
    ds_write_b32 v168, v212
L_L_RD0:
    s_add_u32 m0, s90, 5120
    s_nop 0
    buffer_load_dwordx4 v9, s[60:63], s17 offen offset:0  lds
    s_add_u32 m0, s90, 120832
    s_add_u32 s17, s89, 88128
    buffer_load_dwordx4 v8, s[60:63], s17 offen offset:0  lds
    s_add_u32 m0, s90, 6144
    s_nop 0
    buffer_load_dwordx4 v9, s[60:63], s17 offen offset:0  lds
    s_add_u32 m0, s90, 121856
    s_add_u32 s17, s89, 132160
    buffer_load_dwordx4 v8, s[60:63], s17 offen offset:0  lds
    s_add_u32 m0, s90, 7168
    s_nop 0
    buffer_load_dwordx4 v9, s[60:63], s17 offen offset:0  lds
    s_add_u32 m0, s90, 32768
    s_add_u32 s17, s91, 0
    buffer_load_dwordx4 v6, s[64:67], s17 offen offset:0  lds
    buffer_load_dwordx4 v7, s[64:67], s17 offen offset:1024  lds
    s_add_u32 m0, s90, 34816
    s_add_u32 s17, s91, 16384
    buffer_load_dwordx4 v6, s[64:67], s17 offen offset:0  lds
    s_cmp_eq_u32 s6, 3
    s_cselect_b32 s84, 2146435072, s97
    s_mul_i32 s85, s4, 614400
    s_lshl_b32 s14, s7, 11
    s_add_u32 s85, s85, s14
    s_lshl_b32 s14, s6, 16
    s_add_u32 s85, s85, s14
    s_add_u32 s85, s85, 352256
    s_lshl_b32 s86, s8, 16
    s_lshl_b32 s14, s6, 8
    s_add_u32 s86, s86, s14
    s_lshl_b32 s87, s4, 2
    s_add_u32 s87, s87, s6
    s_lshl_b32 s87, s87, 1
    s_add_u32 s87, s87, s7
    s_lshl_b32 s87, s87, 9
    s_add_u32 s87, s87, 10747904
    s_waitcnt lgkmcnt(0)
    s_barrier
    s_cmp_lg_u32 s6, 3
    s_cbranch_scc1 L_L_NOPUB
    v_lshlrev_b32 v136, 4, v1
    v_lshl_add_u32 v137, v2, 11, v136
    v_add_u32 v137, 147456, v137
    ds_read_b128 v[40:43], v137 offset:0
    ds_read_b128 v[44:47], v137 offset:512
    ds_read_b128 v[48:51], v137 offset:1024
    ds_read_b128 v[52:55], v137 offset:1536
    s_lshl_b32 s14, s5, 4
    s_add_u32 s14, s14, s4
    s_lshl_b32 s14, s14, 9
    s_add_u32 s14, s14, 10551296
    s_waitcnt lgkmcnt(3)
    v_pk_fma_f32 v[142:143], v[40:41], v[200:201], v[42:43] op_sel_hi:[1,0,1]
    v_pk_fma_f32 v[142:143], v[40:41], v[202:203], v[142:143] op_sel:[1,0,0] op_sel_hi:[0,1,1]
    s_waitcnt lgkmcnt(2)
    v_pk_fma_f32 v[140:141], v[142:143], v[200:201], v[44:45] op_sel_hi:[1,0,1]
    v_pk_fma_f32 v[140:141], v[142:143], v[202:203], v[140:141] op_sel:[1,0,0] op_sel_hi:[0,1,1]
    v_pk_fma_f32 v[142:143], v[140:141], v[200:201], v[46:47] op_sel_hi:[1,0,1]
    v_pk_fma_f32 v[142:143], v[140:141], v[202:203], v[142:143] op_sel:[1,0,0] op_sel_hi:[0,1,1]
    s_waitcnt lgkmcnt(1)
    v_pk_fma_f32 v[140:141], v[142:143], v[200:201], v[48:49] op_sel_hi:[1,0,1]
    v_pk_fma_f32 v[140:141], v[142:143], v[202:203], v[140:141] op_sel:[1,0,0] op_sel_hi:[0,1,1]
    v_pk_fma_f32 v[142:143], v[140:141], v[200:201], v[50:51] op_sel_hi:[1,0,1]
    v_pk_fma_f32 v[142:143], v[140:141], v[202:203], v[142:143] op_sel:[1,0,0] op_sel_hi:[0,1,1]
    s_waitcnt lgkmcnt(0)
    v_pk_fma_f32 v[140:141], v[142:143], v[200:201], v[52:53] op_sel_hi:[1,0,1]
    v_pk_fma_f32 v[140:141], v[142:143], v[202:203], v[140:141] op_sel:[1,0,0] op_sel_hi:[0,1,1]
    v_pk_fma_f32 v[142:143], v[140:141], v[200:201], v[54:55] op_sel_hi:[1,0,1]
    v_pk_fma_f32 v[142:143], v[140:141], v[202:203], v[142:143] op_sel:[1,0,0] op_sel_hi:[0,1,1]
    v_mov_b32 v40, v142
    v_mov_b32 v41, v143
    s_nop 1
    v_permlane32_swap_b32 v142, v40
    v_permlane32_swap_b32 v143, v41
    s_nop 0
    v_pk_fma_f32 v[140:141], v[142:143], v[232:233], v[40:41] op_sel_hi:[1,0,1]
    v_pk_fma_f32 v[140:141], v[142:143], v[234:235], v[140:141] op_sel:[1,0,0] op_sel_hi:[0,1,1]
    v_mov_b32 v142, s12
    v_mov_b32 v143, s12
    buffer_store_dwordx4 v[140:143], v136, s[76:79], s14 offen sc1
L_L_NOPUB:
    buffer_load_dwordx4 v7, s[64:67], s17 offen offset:1024  lds
    s_add_u32 m0, s90, 36864
    s_add_u32 s17, s92, 0
    buffer_load_dwordx4 v6, s[64:67], s17 offen offset:0  lds
    buffer_load_dwordx4 v7, s[64:67], s17 offen offset:1024  lds
    s_add_u32 m0, s90, 38912
    s_add_u32 s17, s92, 16384
    buffer_load_dwordx4 v6, s[64:67], s17 offen offset:0  lds
    buffer_load_dwordx4 v7, s[64:67], s17 offen offset:1024  lds
    s_add_u32 m0, s90, 65536
    s_add_u32 s17, s93, 0
    buffer_load_dwordx4 v6, s[64:67], s17 offen offset:0  lds
    buffer_load_dwordx4 v7, s[64:67], s17 offen offset:1024  lds
    s_add_u32 m0, s90, 67584
    s_add_u32 s17, s93, 16384
    buffer_load_dwordx4 v6, s[64:67], s17 offen offset:0  lds
    buffer_load_dwordx4 v7, s[64:67], s17 offen offset:1024  lds
    s_add_u32 m0, s90, 69632
    s_add_u32 s17, s94, 0
    buffer_load_dwordx4 v6, s[64:67], s17 offen offset:0  lds
    buffer_load_dwordx4 v7, s[64:67], s17 offen offset:1024  lds
    s_waitcnt vmcnt(14)
    s_lshl_b32 s14, s6, 2
    s_add_u32 s14, s14, 163344
    v_mov_b32 v248, s14
    ds_write_b32 v248, v244
    s_add_u32 m0, s90, 71680
    s_add_u32 s17, s94, 16384
    buffer_load_dwordx4 v6, s[64:67], s17 offen offset:0  lds
    buffer_load_dwordx4 v7, s[64:67], s17 offen offset:1024  lds
    v_add_u32 v228, 114688, v247
    s_waitcnt vmcnt(14)
    ds_read_b64_tr_b16 v[24:25], v12 offset:32768
    ds_read_b64_tr_b16 v[26:27], v12 offset:33792
    ds_read_b64_tr_b16 v[28:29], v13 offset:32768
    ds_read_b64_tr_b16 v[30:31], v13 offset:33792
    ds_read_b64_tr_b16 v[168:169], v228 offset:0
    ds_read_b64_tr_b16 v[170:171], v228 offset:256
    ds_read_b64_tr_b16 v[172:173], v228 offset:1024
    ds_read_b64_tr_b16 v[174:175], v228 offset:1280
    s_waitcnt vmcnt(12)
    ds_read_b64_tr_b16 v[32:33], v12 offset:34816
    ds_read_b64_tr_b16 v[34:35], v12 offset:35840
    ds_read_b64_tr_b16 v[36:37], v13 offset:34816
    ds_read_b64_tr_b16 v[38:39], v13 offset:35840
    ds_read_b64_tr_b16 v[176:177], v228 offset:2048
    ds_read_b64_tr_b16 v[178:179], v228 offset:2304
    ds_read_b64_tr_b16 v[180:181], v228 offset:3072
    ds_read_b64_tr_b16 v[182:183], v228 offset:3328
    s_waitcnt lgkmcnt(12)
    s_add_u32 m0, s90, 32768
    s_add_u32 s17, s91, 32768
    buffer_load_dwordx4 v6, s[64:67], s17 offen offset:0  lds
    buffer_load_dwordx4 v7, s[64:67], s17 offen offset:1024  lds
    s_waitcnt lgkmcnt(8)
    v_mfma_f32_4x4x4_16b_bf16 v[212:215], v[244:245], v[168:169], 0
    v_mfma_f32_4x4x4_16b_bf16 v[216:219], v[244:245], v[170:171], 0
    v_mfma_f32_4x4x4_16b_bf16 v[220:223], v[244:245], v[172:173], 0
    v_mfma_f32_4x4x4_16b_bf16 v[224:227], v[244:245], v[174:175], 0
    s_waitcnt vmcnt(12)
    ds_read_b64_tr_b16 v[40:41], v12 offset:36864
    ds_read_b64_tr_b16 v[42:43], v12 offset:37888
    ds_read_b64_tr_b16 v[44:45], v13 offset:36864
    ds_read_b64_tr_b16 v[46:47], v13 offset:37888
    ds_read_b64_tr_b16 v[168:169], v228 offset:4096
    ds_read_b64_tr_b16 v[170:171], v228 offset:4352
    ds_read_b64_tr_b16 v[172:173], v228 offset:5120
    ds_read_b64_tr_b16 v[174:175], v228 offset:5376
    s_waitcnt lgkmcnt(12)
    s_add_u32 m0, s90, 34816
    s_add_u32 s17, s91, 49152
    buffer_load_dwordx4 v6, s[64:67], s17 offen offset:0  lds
    buffer_load_dwordx4 v7, s[64:67], s17 offen offset:1024  lds
    s_waitcnt lgkmcnt(8)
    v_mfma_f32_4x4x4_16b_bf16 v[212:215], v[244:245], v[176:177], v[212:215]
    v_mfma_f32_4x4x4_16b_bf16 v[216:219], v[244:245], v[178:179], v[216:219]
    v_mfma_f32_4x4x4_16b_bf16 v[220:223], v[244:245], v[180:181], v[220:223]
    v_mfma_f32_4x4x4_16b_bf16 v[224:227], v[244:245], v[182:183], v[224:227]
    s_waitcnt vmcnt(12)
    ds_read_b64_tr_b16 v[48:49], v12 offset:38912
    ds_read_b64_tr_b16 v[50:51], v12 offset:39936
    ds_read_b64_tr_b16 v[52:53], v13 offset:38912
    ds_read_b64_tr_b16 v[54:55], v13 offset:39936
    ds_read_b64_tr_b16 v[176:177], v228 offset:6144
    ds_read_b64_tr_b16 v[178:179], v228 offset:6400
    ds_read_b64_tr_b16 v[180:181], v228 offset:7168
    ds_read_b64_tr_b16 v[182:183], v228 offset:7424
    s_waitcnt lgkmcnt(12)
    s_add_u32 m0, s90, 36864
    s_add_u32 s17, s92, 32768
    buffer_load_dwordx4 v6, s[64:67], s17 offen offset:0  lds
    buffer_load_dwordx4 v7, s[64:67], s17 offen offset:1024  lds
    s_waitcnt lgkmcnt(8)
    v_mfma_f32_4x4x4_16b_bf16 v[212:215], v[244:245], v[168:169], v[212:215]
    v_mfma_f32_4x4x4_16b_bf16 v[216:219], v[244:245], v[170:171], v[216:219]
    v_mfma_f32_4x4x4_16b_bf16 v[220:223], v[244:245], v[172:173], v[220:223]
    v_mfma_f32_4x4x4_16b_bf16 v[224:227], v[244:245], v[174:175], v[224:227]
    s_waitcnt vmcnt(12)
    ds_read_b64_tr_b16 v[56:57], v14 offset:0
    ds_read_b64_tr_b16 v[58:59], v14 offset:1024
    ds_read_b64_tr_b16 v[60:61], v15 offset:0
    ds_read_b64_tr_b16 v[62:63], v15 offset:1024
    s_waitcnt lgkmcnt(8)
    s_add_u32 m0, s90, 38912
    s_add_u32 s17, s92, 49152
    buffer_load_dwordx4 v6, s[64:67], s17 offen offset:0  lds
    buffer_load_dwordx4 v7, s[64:67], s17 offen offset:1024  lds
    s_waitcnt lgkmcnt(4)
    v_mfma_f32_4x4x4_16b_bf16 v[212:215], v[244:245], v[176:177], v[212:215]
    v_mfma_f32_4x4x4_16b_bf16 v[216:219], v[244:245], v[178:179], v[216:219]
    v_mfma_f32_4x4x4_16b_bf16 v[220:223], v[244:245], v[180:181], v[220:223]
    v_mfma_f32_4x4x4_16b_bf16 v[224:227], v[244:245], v[182:183], v[224:227]
    s_nop 0
    s_lshl_b32 s14, s6, 7
    s_add_u32 s14, s14, 98304
    v_lshl_add_u32 v184, v1, 2, s14
    s_nop 1
    v_add_f32 v212, v212, v216
    v_add_f32 v220, v220, v224
    v_add_f32 v212, v212, v220
    v_mov_b32 v213, v212
    s_nop 1
    v_permlane32_swap_b32 v212, v213
    v_add_f32 v212, v212, v213
    ds_write_b32 v184, v212
    s_lshl_b32 s14, s6, 2
    s_add_u32 s14, s14, 163360
    v_mov_b32 v248, s14
    ds_write_b32 v248, v244
    s_waitcnt vmcnt(12)
    ds_read_b64_tr_b16 v[64:65], v14 offset:2048
    ds_read_b64_tr_b16 v[66:67], v14 offset:3072
    ds_read_b64_tr_b16 v[68:69], v15 offset:2048
    ds_read_b64_tr_b16 v[70:71], v15 offset:3072
    v_subrev_u32 v228, 114688, v228
    ds_read_b64_tr_b16 v[176:177], v228 offset:0
    ds_read_b64_tr_b16 v[178:179], v228 offset:256
    ds_read_b64_tr_b16 v[180:181], v228 offset:1024
    ds_read_b64_tr_b16 v[182:183], v228 offset:1280
    s_waitcnt lgkmcnt(10)
    s_add_u32 m0, s90, 65536
    s_add_u32 s17, s93, 32768
    buffer_load_dwordx4 v6, s[64:67], s17 offen offset:0  lds
    buffer_load_dwordx4 v7, s[64:67], s17 offen offset:1024  lds
    s_waitcnt vmcnt(12)
    ds_read_b64_tr_b16 v[72:73], v14 offset:4096
    ds_read_b64_tr_b16 v[74:75], v14 offset:5120
    ds_read_b64_tr_b16 v[76:77], v15 offset:4096
    ds_read_b64_tr_b16 v[78:79], v15 offset:5120
    ds_read_b64_tr_b16 v[168:169], v228 offset:2048
    ds_read_b64_tr_b16 v[170:171], v228 offset:2304
    ds_read_b64_tr_b16 v[172:173], v228 offset:3072
    ds_read_b64_tr_b16 v[174:175], v228 offset:3328
    s_waitcnt lgkmcnt(12)
    s_add_u32 m0, s90, 67584
    s_add_u32 s17, s93, 49152
    buffer_load_dwordx4 v6, s[64:67], s17 offen offset:0  lds
    buffer_load_dwordx4 v7, s[64:67], s17 offen offset:1024  lds
    s_waitcnt lgkmcnt(8)
    v_mfma_f32_4x4x4_16b_bf16 v[212:215], v[244:245], v[176:177], 0
    v_mfma_f32_4x4x4_16b_bf16 v[216:219], v[244:245], v[178:179], 0
    v_mfma_f32_4x4x4_16b_bf16 v[220:223], v[244:245], v[180:181], 0
    v_mfma_f32_4x4x4_16b_bf16 v[224:227], v[244:245], v[182:183], 0
    s_cmp_lg_u32 s6, 1
    s_cbranch_scc1 L_L_RD1
    v_and_b32 v9, 3, v0
    v_lshlrev_b32 v9, 2, v9
    v_add_u32 v9, 163360, v9
    s_mov_b32 s15, 1600000
L_L_CW0:
    ds_read_b32 v10, v9
    s_sub_u32 s15, s15, 1
    s_waitcnt lgkmcnt(0)
    v_cmp_eq_u32 vcc, 0, v10
    s_cmp_eq_u32 s15, 0
    s_cbranch_scc1 L_L_CD0
    s_cbranch_vccnz L_L_CW0
L_L_CD0:
    v_lshlrev_b32 v184, 2, v1
    v_add_u32 v185, 98304, v184
    v_add_u32 v184, 151680, v184
    ds_read_b32 v188, v185 offset:0
    ds_read_b32 v189, v185 offset:128
    ds_read_b32 v190, v185 offset:256
    ds_read_b32 v191, v185 offset:384
    v_mov_b32 v248, 163408
    s_waitcnt lgkmcnt(0)
    v_add_f32 v188, v188, v189
    v_add_f32 v190, v190, v191
    v_add_f32 v188, v188, v190
    ds_write_b32 v184, v188
    ds_write_b32 v248, v244
L_L_RD1:
    s_waitcnt vmcnt(12)
    ds_read_b64_tr_b16 v[80:81], v14 offset:6144
    ds_read_b64_tr_b16 v[82:83], v14 offset:7168
    ds_read_b64_tr_b16 v[84:85], v15 offset:6144
    ds_read_b64_tr_b16 v[86:87], v15 offset:7168
    ds_read_b64_tr_b16 v[176:177], v228 offset:4096
    ds_read_b64_tr_b16 v[178:179], v228 offset:4352
    ds_read_b64_tr_b16 v[180:181], v228 offset:5120
    ds_read_b64_tr_b16 v[182:183], v228 offset:5376
    s_waitcnt lgkmcnt(12)
    s_add_u32 m0, s90, 69632
    s_add_u32 s17, s94, 32768
    buffer_load_dwordx4 v6, s[64:67], s17 offen offset:0  lds
    buffer_load_dwordx4 v7, s[64:67], s17 offen offset:1024  lds
    s_waitcnt lgkmcnt(8)
    v_mfma_f32_4x4x4_16b_bf16 v[212:215], v[244:245], v[168:169], v[212:215]
    v_mfma_f32_4x4x4_16b_bf16 v[216:219], v[244:245], v[170:171], v[216:219]
    v_mfma_f32_4x4x4_16b_bf16 v[220:223], v[244:245], v[172:173], v[220:223]
    v_mfma_f32_4x4x4_16b_bf16 v[224:227], v[244:245], v[174:175], v[224:227]
    s_waitcnt vmcnt(12)
    ds_read_b64_tr_b16 v[88:89], v12 offset:32768
    ds_read_b64_tr_b16 v[90:91], v12 offset:33792
    ds_read_b64_tr_b16 v[92:93], v13 offset:32768
    ds_read_b64_tr_b16 v[94:95], v13 offset:33792
    ds_read_b64_tr_b16 v[168:169], v228 offset:6144
    ds_read_b64_tr_b16 v[170:171], v228 offset:6400
    ds_read_b64_tr_b16 v[172:173], v228 offset:7168
    ds_read_b64_tr_b16 v[174:175], v228 offset:7424
    s_waitcnt lgkmcnt(12)
    s_add_u32 m0, s90, 71680
    s_add_u32 s17, s94, 49152
    buffer_load_dwordx4 v6, s[64:67], s17 offen offset:0  lds
    buffer_load_dwordx4 v7, s[64:67], s17 offen offset:1024  lds
    s_waitcnt lgkmcnt(8)
    v_mfma_f32_4x4x4_16b_bf16 v[212:215], v[244:245], v[176:177], v[212:215]
    v_mfma_f32_4x4x4_16b_bf16 v[216:219], v[244:245], v[178:179], v[216:219]
    v_mfma_f32_4x4x4_16b_bf16 v[220:223], v[244:245], v[180:181], v[220:223]
    v_mfma_f32_4x4x4_16b_bf16 v[224:227], v[244:245], v[182:183], v[224:227]
    s_waitcnt vmcnt(12)
    ds_read_b64_tr_b16 v[96:97], v12 offset:34816
    ds_read_b64_tr_b16 v[98:99], v12 offset:35840
    ds_read_b64_tr_b16 v[100:101], v13 offset:34816
    ds_read_b64_tr_b16 v[102:103], v13 offset:35840
    s_waitcnt lgkmcnt(8)
    s_add_u32 m0, s90, 32768
    s_add_u32 s17, s91, 65536
    buffer_load_dwordx4 v6, s[64:67], s17 offen offset:0  lds
    buffer_load_dwordx4 v7, s[64:67], s17 offen offset:1024  lds
    s_waitcnt lgkmcnt(4)
    v_mfma_f32_4x4x4_16b_bf16 v[212:215], v[244:245], v[168:169], v[212:215]
    v_mfma_f32_4x4x4_16b_bf16 v[216:219], v[244:245], v[170:171], v[216:219]
    v_mfma_f32_4x4x4_16b_bf16 v[220:223], v[244:245], v[172:173], v[220:223]
    v_mfma_f32_4x4x4_16b_bf16 v[224:227], v[244:245], v[174:175], v[224:227]
    s_nop 0
    s_lshl_b32 s14, s6, 7
    s_add_u32 s14, s14, 98816
    v_lshl_add_u32 v184, v1, 2, s14
    s_nop 1
    v_add_f32 v212, v212, v216
    v_add_f32 v220, v220, v224
    v_add_f32 v212, v212, v220
    v_mov_b32 v213, v212
    s_nop 1
    v_permlane32_swap_b32 v212, v213
    v_add_f32 v212, v212, v213
    ds_write_b32 v184, v212
    s_lshl_b32 s14, s6, 2
    s_add_u32 s14, s14, 163680
    v_mov_b32 v248, s14
    ds_write_b32 v248, v244
    s_waitcnt vmcnt(12)
    ds_read_b64_tr_b16 v[104:105], v12 offset:36864
    ds_read_b64_tr_b16 v[106:107], v12 offset:37888
    ds_read_b64_tr_b16 v[108:109], v13 offset:36864
    ds_read_b64_tr_b16 v[110:111], v13 offset:37888
    s_waitcnt lgkmcnt(6)
    s_add_u32 m0, s90, 34816
    s_add_u32 s17, s91, 81920
    buffer_load_dwordx4 v6, s[64:67], s17 offen offset:0  lds
    buffer_load_dwordx4 v7, s[64:67], s17 offen offset:1024  lds
    v_lshlrev_b32 v136, 4, v1
    s_sub_u32 s15, s4, 1
    v_lshlrev_b32 v137, 3, v2
    v_sub_u32 v137, s15, v137
    v_lshl_add_u32 v138, v137, 9, v136
    v_mov_b32 v139, 2146435072
    v_mov_b32 v160, s12
    v_cmp_le_i32 vcc, 0, v137
    v_subrev_u32 v144, 0, v138
    s_nop 0
    v_cndmask_b32 v144, v139, v144, vcc
    v_cndmask_b32 v152, 0, v160, vcc
    v_cmp_le_i32 vcc, 1, v137
    v_subrev_u32 v145, 512, v138
    s_nop 0
    v_cndmask_b32 v145, v139, v145, vcc
    v_cndmask_b32 v153, 0, v160, vcc
    v_cmp_le_i32 vcc, 2, v137
    v_subrev_u32 v146, 1024, v138
    s_nop 0
    v_cndmask_b32 v146, v139, v146, vcc
    v_cndmask_b32 v154, 0, v160, vcc
    v_cmp_le_i32 vcc, 3, v137
    v_subrev_u32 v147, 1536, v138
    s_nop 0
    v_cndmask_b32 v147, v139, v147, vcc
    v_cndmask_b32 v155, 0, v160, vcc
    v_cmp_le_i32 vcc, 4, v137
    v_subrev_u32 v148, 2048, v138
    s_nop 0
    v_cndmask_b32 v148, v139, v148, vcc
    v_cndmask_b32 v156, 0, v160, vcc
    v_cmp_le_i32 vcc, 5, v137
    v_subrev_u32 v149, 2560, v138
    s_nop 0
    v_cndmask_b32 v149, v139, v149, vcc
    v_cndmask_b32 v157, 0, v160, vcc
    v_cmp_le_i32 vcc, 6, v137
    v_subrev_u32 v150, 3072, v138
    s_nop 0
    v_cndmask_b32 v150, v139, v150, vcc
    v_cndmask_b32 v158, 0, v160, vcc
    v_cmp_le_i32 vcc, 7, v137
    v_subrev_u32 v151, 3584, v138
    s_nop 0
    v_cndmask_b32 v151, v139, v151, vcc
    v_cndmask_b32 v159, 0, v160, vcc
    s_lshl_b32 s82, s5, 13
    s_add_u32 s82, s82, 10551296
    s_cmp_lg_u32 s6, 3
    s_cbranch_scc1 L_L_LBI
    buffer_load_dwordx4 v[168:171], v144, s[76:79], s82 offen sc1
    buffer_load_dwordx4 v[172:175], v145, s[76:79], s82 offen sc1
    buffer_load_dwordx4 v[176:179], v146, s[76:79], s82 offen sc1
    buffer_load_dwordx4 v[180:183], v147, s[76:79], s82 offen sc1
    buffer_load_dwordx4 v[184:187], v148, s[76:79], s82 offen sc1
    buffer_load_dwordx4 v[188:191], v149, s[76:79], s82 offen sc1
    buffer_load_dwordx4 v[192:195], v150, s[76:79], s82 offen sc1
    buffer_load_dwordx4 v[196:199], v151, s[76:79], s82 offen sc1
L_L_LBI:
    s_waitcnt vmcnt(12)
    ds_read_b64_tr_b16 v[112:113], v12 offset:38912
    ds_read_b64_tr_b16 v[114:115], v12 offset:39936
    ds_read_b64_tr_b16 v[116:117], v13 offset:38912
    ds_read_b64_tr_b16 v[118:119], v13 offset:39936
    s_waitcnt lgkmcnt(4)
    s_add_u32 m0, s90, 36864
    s_add_u32 s17, s92, 65536
    buffer_load_dwordx4 v6, s[64:67], s17 offen offset:0  lds
    buffer_load_dwordx4 v7, s[64:67], s17 offen offset:1024  lds
    s_cmp_lg_u32 s6, 2
    s_cbranch_scc1 L_L_RD2
    v_and_b32 v9, 3, v0
    v_lshlrev_b32 v9, 2, v9
    v_add_u32 v9, 163680, v9
    s_mov_b32 s15, 1600000
L_L_CW20:
    ds_read_b32 v10, v9
    s_sub_u32 s15, s15, 1
    s_waitcnt lgkmcnt(0)
    v_cmp_eq_u32 vcc, 0, v10
    s_cmp_eq_u32 s15, 0
    s_cbranch_scc1 L_L_CD20
    s_cbranch_vccnz L_L_CW20
L_L_CD20:
    v_lshlrev_b32 v184, 2, v1
    v_add_u32 v185, 98816, v184
    v_add_u32 v184, 151808, v184
    ds_read_b32 v188, v185 offset:0
    ds_read_b32 v189, v185 offset:128
    ds_read_b32 v190, v185 offset:256
    ds_read_b32 v191, v185 offset:384
    v_mov_b32 v248, 163412
    s_waitcnt lgkmcnt(0)
    v_add_f32 v188, v188, v189
    v_add_f32 v190, v190, v191
    v_add_f32 v188, v188, v190
    ds_write_b32 v184, v188
    ds_write_b32 v248, v244
L_L_RD2:
    s_waitcnt vmcnt(12)
    ds_read_b64_tr_b16 v[120:121], v14 offset:0
    ds_read_b64_tr_b16 v[122:123], v14 offset:1024
    ds_read_b64_tr_b16 v[124:125], v15 offset:0
    ds_read_b64_tr_b16 v[126:127], v15 offset:1024
    s_waitcnt lgkmcnt(4)
    s_add_u32 m0, s90, 38912
    s_add_u32 s17, s92, 81920
    buffer_load_dwordx4 v6, s[64:67], s17 offen offset:0  lds
    buffer_load_dwordx4 v7, s[64:67], s17 offen offset:1024  lds
    s_cmp_lg_u32 s6, 3
    s_cbranch_scc1 L_L_LBE
    s_mov_b32 s15, 200000
    s_waitcnt vmcnt(4)
    s_branch L_L_LBC
L_L_LB:
    buffer_load_dwordx4 v[168:171], v144, s[76:79], s82 offen sc1
    buffer_load_dwordx4 v[172:175], v145, s[76:79], s82 offen sc1
    buffer_load_dwordx4 v[176:179], v146, s[76:79], s82 offen sc1
    buffer_load_dwordx4 v[180:183], v147, s[76:79], s82 offen sc1
    buffer_load_dwordx4 v[184:187], v148, s[76:79], s82 offen sc1
    buffer_load_dwordx4 v[188:191], v149, s[76:79], s82 offen sc1
    buffer_load_dwordx4 v[192:195], v150, s[76:79], s82 offen sc1
    buffer_load_dwordx4 v[196:199], v151, s[76:79], s82 offen sc1
    s_waitcnt vmcnt(0)
L_L_LBC:
    s_mov_b64 s[88:89], 0
    s_sub_u32 s15, s15, 1
    v_cmp_ne_u32 vcc, v170, v152
    s_or_b64 s[88:89], s[88:89], vcc
    v_cmp_ne_u32 vcc, v174, v153
    s_or_b64 s[88:89], s[88:89], vcc
    v_cmp_ne_u32 vcc, v178, v154
    s_or_b64 s[88:89], s[88:89], vcc
    v_cmp_ne_u32 vcc, v182, v155
    s_or_b64 s[88:89], s[88:89], vcc
    v_cmp_ne_u32 vcc, v186, v156
    s_or_b64 s[88:89], s[88:89], vcc
    v_cmp_ne_u32 vcc, v190, v157
    s_or_b64 s[88:89], s[88:89], vcc
    v_cmp_ne_u32 vcc, v194, v158
    s_or_b64 s[88:89], s[88:89], vcc
    v_cmp_ne_u32 vcc, v198, v159
    s_or_b64 s[88:89], s[88:89], vcc
    s_cmp_eq_u32 s15, 0
    s_cbranch_scc1 L_L_LBOK
    s_cmp_lg_u64 s[88:89], 0
    s_cbranch_scc1 L_L_LB
L_L_LBOK:
    v_pk_fma_f32 v[140:141], v[196:197], v[204:205], v[192:193] op_sel_hi:[1,0,1]
    v_pk_fma_f32 v[140:141], v[196:197], v[206:207], v[140:141] op_sel:[1,0,0] op_sel_hi:[0,1,1]
    v_pk_fma_f32 v[142:143], v[140:141], v[204:205], v[188:189] op_sel_hi:[1,0,1]
    v_pk_fma_f32 v[142:143], v[140:141], v[206:207], v[142:143] op_sel:[1,0,0] op_sel_hi:[0,1,1]
    v_pk_fma_f32 v[140:141], v[142:143], v[204:205], v[184:185] op_sel_hi:[1,0,1]
    v_pk_fma_f32 v[140:141], v[142:143], v[206:207], v[140:141] op_sel:[1,0,0] op_sel_hi:[0,1,1]
    v_pk_fma_f32 v[142:143], v[140:141], v[204:205], v[180:181] op_sel_hi:[1,0,1]
    v_pk_fma_f32 v[142:143], v[140:141], v[206:207], v[142:143] op_sel:[1,0,0] op_sel_hi:[0,1,1]
    v_pk_fma_f32 v[140:141], v[142:143], v[204:205], v[176:177] op_sel_hi:[1,0,1]
    v_pk_fma_f32 v[140:141], v[142:143], v[206:207], v[140:141] op_sel:[1,0,0] op_sel_hi:[0,1,1]
    v_pk_fma_f32 v[142:143], v[140:141], v[204:205], v[172:173] op_sel_hi:[1,0,1]
    v_pk_fma_f32 v[142:143], v[140:141], v[206:207], v[142:143] op_sel:[1,0,0] op_sel_hi:[0,1,1]
    v_pk_fma_f32 v[140:141], v[142:143], v[204:205], v[168:169] op_sel_hi:[1,0,1]
    v_pk_fma_f32 v[140:141], v[142:143], v[206:207], v[140:141] op_sel:[1,0,0] op_sel_hi:[0,1,1]
    v_mov_b32 v142, v140
    v_mov_b32 v143, v141
    s_nop 1
    v_permlane32_swap_b32 v140, v142
    v_permlane32_swap_b32 v141, v143
    s_nop 0
    v_pk_fma_f32 v[144:145], v[142:143], v[208:209], v[140:141] op_sel_hi:[1,0,1]
    v_pk_fma_f32 v[144:145], v[142:143], v[210:211], v[144:145] op_sel:[1,0,0] op_sel_hi:[0,1,1]
    v_lshlrev_b32 v137, 3, v1
    v_add_u32 v137, 152832, v137
    v_mov_b32 v138, 163328
    v_mov_b32 v139, 1
    ds_write_b64 v137, v[144:145]
    ds_write_b32 v138, v139
    s_cmp_lg_u32 s4, 15
    s_cbranch_scc1 L_L_LBE
    s_lshl_b32 s14, s5, 7
    s_add_u32 s14, s14, 10883072
    v_mov_b32 v136, 0
    buffer_store_dword v160, v136, s[76:79], s14 offen sc1
L_L_LBE:
    s_waitcnt vmcnt(12)
    ds_read_b64_tr_b16 v[128:129], v14 offset:2048
    ds_read_b64_tr_b16 v[130:131], v14 offset:3072
    ds_read_b64_tr_b16 v[132:133], v15 offset:2048
    ds_read_b64_tr_b16 v[134:135], v15 offset:3072
    s_waitcnt lgkmcnt(4)
    s_add_u32 m0, s90, 65536
    s_add_u32 s17, s99, 65536
    buffer_load_dwordx4 v6, s[64:67], s17 offen offset:0  lds
    buffer_load_dwordx4 v7, s[64:67], s17 offen offset:1024  lds
    s_waitcnt lgkmcnt(0)
    s_add_u32 m0, s90, 67584
    s_add_u32 s17, s99, 81920
    buffer_load_dwordx4 v6, s[64:67], s17 offen offset:0  lds
    buffer_load_dwordx4 v7, s[64:67], s17 offen offset:1024  lds
    s_add_u32 s24, s50, s87
    s_addc_u32 s25, s51, 0
    s_mov_b32 s26, s11
    s_mov_b32 s27, s11
    v_and_b32 v9, 3, v0
    v_lshlrev_b32 v9, 2, v9
    v_add_u32 v9, 163376, v9
    s_mov_b32 s15, 1600000
L_L_CW1:
    ds_read_b32 v10, v9
    s_sub_u32 s15, s15, 1
    s_waitcnt lgkmcnt(0)
    v_cmp_eq_u32 vcc, 0, v10
    s_cmp_eq_u32 s15, 0
    s_cbranch_scc1 L_L_CD1
    s_cbranch_vccnz L_L_CW1
L_L_CD1:
    s_load_dwordx8 s[28:35], s[24:25], 0 glc
    s_add_u32 m0, s90, 114688
    s_add_u32 s17, s86, 0
    buffer_load_dwordx4 v4, s[68:71], s17 offen offset:0  lds
    buffer_load_dwordx4 v5, s[68:71], s17 offen offset:1024  lds
    s_add_u32 m0, s90, 116736
    s_add_u32 s17, s86, 16384
    buffer_load_dwordx4 v4, s[68:71], s17 offen offset:0  lds
    buffer_load_dwordx4 v5, s[68:71], s17 offen offset:1024  lds
    s_add_u32 m0, s90, 118784
    s_add_u32 s17, s86, 32768
    buffer_load_dwordx4 v4, s[68:71], s17 offen offset:0  lds
    buffer_load_dwordx4 v5, s[68:71], s17 offen offset:1024  lds
    s_add_u32 m0, s90, 120832
    s_add_u32 s17, s86, 49152
    buffer_load_dwordx4 v4, s[68:71], s17 offen offset:0  lds
    buffer_load_dwordx4 v5, s[68:71], s17 offen offset:1024  lds
    s_setprio 1
    s_mov_b32 s15, 200000
L_L_W0:
    s_waitcnt lgkmcnt(0)
    s_xor_b64 s[28:29], s[28:29], s[26:27]
    s_xor_b64 s[30:31], s[30:31], s[26:27]
    s_xor_b64 s[32:33], s[32:33], s[26:27]
    s_xor_b64 s[34:35], s[34:35], s[26:27]
    s_or_b64 s[28:29], s[28:29], s[30:31]
    s_or_b64 s[32:33], s[32:33], s[34:35]
    s_or_b64 s[28:29], s[28:29], s[32:33]
    s_cbranch_scc0 L_L_Q0
    s_sub_u32 s15, s15, 1
    s_cbranch_scc1 L_L_Q0
    s_load_dwordx8 s[28:35], s[24:25], 0 glc
    s_branch L_L_W0
L_L_Q0:
    s_add_u32 s14, s95, 0
    buffer_load_dwordx4 v[200:203], v11, s[76:79], s14 offen offset:0 sc1
    buffer_load_dwordx4 v[204:207], v11, s[76:79], s14 offen offset:1024 sc1
    s_add_u32 s14, s95, 4096
    buffer_load_dwordx4 v[208:211], v11, s[76:79], s14 offen offset:0 sc1
    buffer_load_dwordx4 v[212:215], v11, s[76:79], s14 offen offset:1024 sc1
    s_add_u32 s14, s96, 0
    buffer_load_dwordx4 v[216:219], v11, s[76:79], s14 offen offset:0 sc1
    buffer_load_dwordx4 v[220:223], v11, s[76:79], s14 offen offset:1024 sc1
    s_add_u32 s14, s96, 4096
    buffer_load_dwordx4 v[224:227], v11, s[76:79], s14 offen offset:0 sc1
    buffer_load_dwordx4 v[228:231], v11, s[76:79], s14 offen offset:1024 sc1
    s_add_u32 s14, s97, 0
    buffer_load_dwordx4 v[232:235], v11, s[76:79], s14 offen offset:0 sc1
    buffer_load_dwordx4 v[236:239], v11, s[76:79], s14 offen offset:1024 sc1
    s_add_u32 s14, s97, 4096
    buffer_load_dwordx4 v[240:243], v11, s[76:79], s14 offen offset:0 sc1
    buffer_load_dwordx4 v[244:247], v11, s[76:79], s14 offen offset:1024 sc1
    s_add_u32 s14, s98, 0
    buffer_load_dwordx4 v[248:251], v11, s[76:79], s14 offen offset:0 sc1
    buffer_load_dwordx4 v[252:255], v11, s[76:79], s14 offen offset:1024 sc1
    s_load_dwordx8 s[28:35], s[24:25], 128 glc
    s_waitcnt vmcnt(12)
    v_mfma_f32_32x32x16_bf16 v[136:151], v[24:27], v[200:203], 0
    v_mfma_f32_32x32x16_bf16 v[168:183], v[24:27], v[204:207], 0
    v_mfma_f32_32x32x16_bf16 v[152:167], v[28:31], v[200:203], 0
    v_mfma_f32_32x32x16_bf16 v[184:199], v[28:31], v[204:207], 0
    ds_read_b64_tr_b16 v[24:25], v14 offset:4096
    ds_read_b64_tr_b16 v[26:27], v14 offset:5120
    ds_read_b64_tr_b16 v[28:29], v15 offset:4096
    ds_read_b64_tr_b16 v[30:31], v15 offset:5120
    s_waitcnt vmcnt(10)
    v_mfma_f32_32x32x16_bf16 v[136:151], v[32:35], v[208:211], v[136:151]
    v_mfma_f32_32x32x16_bf16 v[168:183], v[32:35], v[212:215], v[168:183]
    v_mfma_f32_32x32x16_bf16 v[152:167], v[36:39], v[208:211], v[152:167]
    v_mfma_f32_32x32x16_bf16 v[184:199], v[36:39], v[212:215], v[184:199]
    ds_read_b64_tr_b16 v[32:33], v14 offset:6144
    ds_read_b64_tr_b16 v[34:35], v14 offset:7168
    ds_read_b64_tr_b16 v[36:37], v15 offset:6144
    ds_read_b64_tr_b16 v[38:39], v15 offset:7168
    s_add_u32 s14, s98, 4096
    buffer_load_dwordx4 v[200:203], v11, s[76:79], s14 offen offset:0 sc1
    buffer_load_dwordx4 v[204:207], v11, s[76:79], s14 offen offset:1024 sc1
    s_waitcnt vmcnt(10)
    v_mfma_f32_32x32x16_bf16 v[136:151], v[40:43], v[216:219], v[136:151]
    v_mfma_f32_32x32x16_bf16 v[168:183], v[40:43], v[220:223], v[168:183]
    v_mfma_f32_32x32x16_bf16 v[152:167], v[44:47], v[216:219], v[152:167]
    v_mfma_f32_32x32x16_bf16 v[184:199], v[44:47], v[220:223], v[184:199]
    ds_read_b64_tr_b16 v[40:41], v12 offset:32768
    ds_read_b64_tr_b16 v[42:43], v12 offset:33792
    ds_read_b64_tr_b16 v[44:45], v13 offset:32768
    ds_read_b64_tr_b16 v[46:47], v13 offset:33792
    s_mov_b32 s15, 200000
L_L_W1:
    s_waitcnt lgkmcnt(0)
    s_xor_b64 s[28:29], s[28:29], s[26:27]
    s_xor_b64 s[30:31], s[30:31], s[26:27]
    s_xor_b64 s[32:33], s[32:33], s[26:27]
    s_xor_b64 s[34:35], s[34:35], s[26:27]
    s_or_b64 s[28:29], s[28:29], s[30:31]
    s_or_b64 s[32:33], s[32:33], s[34:35]
    s_or_b64 s[28:29], s[28:29], s[32:33]
    s_cbranch_scc0 L_L_Q1
    s_sub_u32 s15, s15, 1
    s_cbranch_scc1 L_L_Q1
    s_load_dwordx8 s[28:35], s[24:25], 128 glc
    s_branch L_L_W1
L_L_Q1:
    s_add_u32 s14, s95, 8192
    buffer_load_dwordx4 v[208:211], v11, s[76:79], s14 offen offset:0 sc1
    buffer_load_dwordx4 v[212:215], v11, s[76:79], s14 offen offset:1024 sc1
    s_load_dwordx8 s[28:35], s[24:25], 256 glc
    s_waitcnt vmcnt(10)
    v_mfma_f32_32x32x16_bf16 v[136:151], v[48:51], v[224:227], v[136:151]
    v_mfma_f32_32x32x16_bf16 v[168:183], v[48:51], v[228:231], v[168:183]
    v_mfma_f32_32x32x16_bf16 v[152:167], v[52:55], v[224:227], v[152:167]
    v_mfma_f32_32x32x16_bf16 v[184:199], v[52:55], v[228:231], v[184:199]
    ds_read_b64_tr_b16 v[48:49], v12 offset:34816
    ds_read_b64_tr_b16 v[50:51], v12 offset:35840
    ds_read_b64_tr_b16 v[52:53], v13 offset:34816
    ds_read_b64_tr_b16 v[54:55], v13 offset:35840
    s_add_u32 s14, s95, 12288
    buffer_load_dwordx4 v[216:219], v11, s[76:79], s14 offen offset:0 sc1
    buffer_load_dwordx4 v[220:223], v11, s[76:79], s14 offen offset:1024 sc1
    s_waitcnt vmcnt(10)
    v_mfma_f32_32x32x16_bf16 v[136:151], v[56:59], v[232:235], v[136:151]
    v_mfma_f32_32x32x16_bf16 v[168:183], v[56:59], v[236:239], v[168:183]
    v_mfma_f32_32x32x16_bf16 v[152:167], v[60:63], v[232:235], v[152:167]
    v_mfma_f32_32x32x16_bf16 v[184:199], v[60:63], v[236:239], v[184:199]
    ds_read_b64_tr_b16 v[56:57], v12 offset:36864
    ds_read_b64_tr_b16 v[58:59], v12 offset:37888
    ds_read_b64_tr_b16 v[60:61], v13 offset:36864
    ds_read_b64_tr_b16 v[62:63], v13 offset:37888
    s_add_u32 s14, s96, 8192
    buffer_load_dwordx4 v[224:227], v11, s[76:79], s14 offen offset:0 sc1
    buffer_load_dwordx4 v[228:231], v11, s[76:79], s14 offen offset:1024 sc1
    s_waitcnt vmcnt(10)
    v_mfma_f32_32x32x16_bf16 v[136:151], v[64:67], v[240:243], v[136:151]
    v_mfma_f32_32x32x16_bf16 v[168:183], v[64:67], v[244:247], v[168:183]
    v_mfma_f32_32x32x16_bf16 v[152:167], v[68:71], v[240:243], v[152:167]
    v_mfma_f32_32x32x16_bf16 v[184:199], v[68:71], v[244:247], v[184:199]
    ds_read_b64_tr_b16 v[64:65], v12 offset:38912
    ds_read_b64_tr_b16 v[66:67], v12 offset:39936
    ds_read_b64_tr_b16 v[68:69], v13 offset:38912
    ds_read_b64_tr_b16 v[70:71], v13 offset:39936
    s_add_u32 s14, s96, 12288
    buffer_load_dwordx4 v[232:235], v11, s[76:79], s14 offen offset:0 sc1
    buffer_load_dwordx4 v[236:239], v11, s[76:79], s14 offen offset:1024 sc1
    s_waitcnt vmcnt(10)
    v_mfma_f32_32x32x16_bf16 v[136:151], v[72:75], v[248:251], v[136:151]
    v_mfma_f32_32x32x16_bf16 v[168:183], v[72:75], v[252:255], v[168:183]
    v_mfma_f32_32x32x16_bf16 v[152:167], v[76:79], v[248:251], v[152:167]
    v_mfma_f32_32x32x16_bf16 v[184:199], v[76:79], v[252:255], v[184:199]
    ds_read_b64_tr_b16 v[72:73], v14 offset:0
    ds_read_b64_tr_b16 v[74:75], v14 offset:1024
    ds_read_b64_tr_b16 v[76:77], v15 offset:0
    ds_read_b64_tr_b16 v[78:79], v15 offset:1024
    s_add_u32 s14, s97, 8192
    buffer_load_dwordx4 v[240:243], v11, s[76:79], s14 offen offset:0 sc1
    buffer_load_dwordx4 v[244:247], v11, s[76:79], s14 offen offset:1024 sc1
    v_and_b32 v9, 3, v0
    v_lshlrev_b32 v9, 2, v9
    v_add_u32 v9, 163392, v9
    s_mov_b32 s15, 1600000
L_L_CW2:
    ds_read_b32 v10, v9
    s_sub_u32 s15, s15, 1
    s_waitcnt lgkmcnt(0)
    v_cmp_eq_u32 vcc, 0, v10
    s_cmp_eq_u32 s15, 0
    s_cbranch_scc1 L_L_CD2
    s_cbranch_vccnz L_L_CW2
L_L_CD2:
    s_add_u32 m0, s90, 0
    s_add_u32 s17, s86, 0
    buffer_load_dwordx4 v4, s[72:75], s17 offen offset:0  lds
    buffer_load_dwordx4 v5, s[72:75], s17 offen offset:1024  lds
    s_waitcnt vmcnt(12)
    v_mfma_f32_32x32x16_bf16 v[136:151], v[80:83], v[200:203], v[136:151]
    v_mfma_f32_32x32x16_bf16 v[168:183], v[80:83], v[204:207], v[168:183]
    v_mfma_f32_32x32x16_bf16 v[152:167], v[84:87], v[200:203], v[152:167]
    v_mfma_f32_32x32x16_bf16 v[184:199], v[84:87], v[204:207], v[184:199]
    ds_read_b64_tr_b16 v[80:81], v14 offset:2048
    ds_read_b64_tr_b16 v[82:83], v14 offset:3072
    ds_read_b64_tr_b16 v[84:85], v15 offset:2048
    ds_read_b64_tr_b16 v[86:87], v15 offset:3072
    s_add_u32 s14, s97, 12288
    buffer_load_dwordx4 v[248:251], v11, s[76:79], s14 offen offset:0 sc1
    buffer_load_dwordx4 v[252:255], v11, s[76:79], s14 offen offset:1024 sc1
    s_add_u32 m0, s90, 2048
    s_add_u32 s17, s86, 16384
    buffer_load_dwordx4 v4, s[72:75], s17 offen offset:0  lds
    buffer_load_dwordx4 v5, s[72:75], s17 offen offset:1024  lds
    s_waitcnt vmcnt(14)
    v_mfma_f32_32x32x16_bf16 v[136:151], v[88:91], v[208:211], v[136:151]
    v_mfma_f32_32x32x16_bf16 v[168:183], v[88:91], v[212:215], v[168:183]
    v_mfma_f32_32x32x16_bf16 v[152:167], v[92:95], v[208:211], v[152:167]
    v_mfma_f32_32x32x16_bf16 v[184:199], v[92:95], v[212:215], v[184:199]
    ds_read_b128 v[88:91], v20 offset:49152
    ds_read_b128 v[92:95], v20 offset:53248
    s_add_u32 s14, s98, 8192
    buffer_load_dwordx4 v[200:203], v11, s[76:79], s14 offen offset:0 sc1
    buffer_load_dwordx4 v[204:207], v11, s[76:79], s14 offen offset:1024 sc1
    s_add_u32 m0, s90, 4096
    s_add_u32 s17, s86, 32768
    buffer_load_dwordx4 v4, s[72:75], s17 offen offset:0  lds
    buffer_load_dwordx4 v5, s[72:75], s17 offen offset:1024  lds
    s_waitcnt vmcnt(16)
    v_mfma_f32_32x32x16_bf16 v[136:151], v[96:99], v[216:219], v[136:151]
    v_mfma_f32_32x32x16_bf16 v[168:183], v[96:99], v[220:223], v[168:183]
    v_mfma_f32_32x32x16_bf16 v[152:167], v[100:103], v[216:219], v[152:167]
    v_mfma_f32_32x32x16_bf16 v[184:199], v[100:103], v[220:223], v[184:199]
    ds_read_b128 v[96:99], v21 offset:49152
    ds_read_b128 v[100:103], v21 offset:53248
    s_add_u32 s14, s98, 12288
    buffer_load_dwordx4 v[208:211], v11, s[76:79], s14 offen offset:0 sc1
    buffer_load_dwordx4 v[212:215], v11, s[76:79], s14 offen offset:1024 sc1
    s_add_u32 m0, s90, 6144
    s_add_u32 s17, s86, 49152
    buffer_load_dwordx4 v4, s[72:75], s17 offen offset:0  lds
    buffer_load_dwordx4 v5, s[72:75], s17 offen offset:1024  lds
    s_waitcnt vmcnt(18)
    v_mfma_f32_32x32x16_bf16 v[136:151], v[104:107], v[224:227], v[136:151]
    v_mfma_f32_32x32x16_bf16 v[168:183], v[104:107], v[228:231], v[168:183]
    v_mfma_f32_32x32x16_bf16 v[152:167], v[108:111], v[224:227], v[152:167]
    v_mfma_f32_32x32x16_bf16 v[184:199], v[108:111], v[228:231], v[184:199]
    ds_read_b128 v[104:107], v22 offset:49152
    ds_read_b128 v[108:111], v22 offset:53248
    s_mov_b32 s15, 200000
L_L_W2:
    s_waitcnt lgkmcnt(0)
    s_xor_b64 s[28:29], s[28:29], s[26:27]
    s_xor_b64 s[30:31], s[30:31], s[26:27]
    s_xor_b64 s[32:33], s[32:33], s[26:27]
    s_xor_b64 s[34:35], s[34:35], s[26:27]
    s_or_b64 s[28:29], s[28:29], s[30:31]
    s_or_b64 s[32:33], s[32:33], s[34:35]
    s_or_b64 s[28:29], s[28:29], s[32:33]
    s_cbranch_scc0 L_L_Q2
    s_sub_u32 s15, s15, 1
    s_cbranch_scc1 L_L_Q2
    s_load_dwordx8 s[28:35], s[24:25], 256 glc
    s_branch L_L_W2
L_L_Q2:
    s_add_u32 s14, s95, 16384
    buffer_load_dwordx4 v[216:219], v11, s[76:79], s14 offen offset:0 sc1
    buffer_load_dwordx4 v[220:223], v11, s[76:79], s14 offen offset:1024 sc1
    s_load_dwordx8 s[28:35], s[24:25], 384 glc
    s_add_u32 m0, s90, 32768
    s_add_u32 s17, s86, 128
    buffer_load_dwordx4 v4, s[68:71], s17 offen offset:0  lds
    buffer_load_dwordx4 v5, s[68:71], s17 offen offset:1024  lds
    s_waitcnt vmcnt(20)
    v_mfma_f32_32x32x16_bf16 v[136:151], v[112:115], v[232:235], v[136:151]
    v_mfma_f32_32x32x16_bf16 v[168:183], v[112:115], v[236:239], v[168:183]
    v_mfma_f32_32x32x16_bf16 v[152:167], v[116:119], v[232:235], v[152:167]
    v_mfma_f32_32x32x16_bf16 v[184:199], v[116:119], v[236:239], v[184:199]
    ds_read_b128 v[112:115], v23 offset:49152
    ds_read_b128 v[116:119], v23 offset:53248
    s_add_u32 s14, s95, 20480
    buffer_load_dwordx4 v[224:227], v11, s[76:79], s14 offen offset:0 sc1
    buffer_load_dwordx4 v[228:231], v11, s[76:79], s14 offen offset:1024 sc1
    s_add_u32 m0, s90, 34816
    s_add_u32 s17, s86, 16512
    buffer_load_dwordx4 v4, s[68:71], s17 offen offset:0  lds
    buffer_load_dwordx4 v5, s[68:71], s17 offen offset:1024  lds
    s_waitcnt vmcnt(22)
    v_mfma_f32_32x32x16_bf16 v[136:151], v[120:123], v[240:243], v[136:151]
    v_mfma_f32_32x32x16_bf16 v[168:183], v[120:123], v[244:247], v[168:183]
    v_mfma_f32_32x32x16_bf16 v[152:167], v[124:127], v[240:243], v[152:167]
    v_mfma_f32_32x32x16_bf16 v[184:199], v[124:127], v[244:247], v[184:199]
    s_waitcnt vmcnt(8)
    ds_read_b128 v[120:123], v16 offset:0
    ds_read_b128 v[124:127], v16 offset:4096
    s_add_u32 s14, s96, 16384
    buffer_load_dwordx4 v[232:235], v11, s[76:79], s14 offen offset:0 sc1
    buffer_load_dwordx4 v[236:239], v11, s[76:79], s14 offen offset:1024 sc1
    s_add_u32 m0, s90, 36864
    s_add_u32 s17, s86, 32896
    buffer_load_dwordx4 v4, s[68:71], s17 offen offset:0  lds
    buffer_load_dwordx4 v5, s[68:71], s17 offen offset:1024  lds
    v_mfma_f32_32x32x16_bf16 v[136:151], v[128:131], v[248:251], v[136:151]
    v_mfma_f32_32x32x16_bf16 v[168:183], v[128:131], v[252:255], v[168:183]
    v_mfma_f32_32x32x16_bf16 v[152:167], v[132:135], v[248:251], v[152:167]
    v_mfma_f32_32x32x16_bf16 v[184:199], v[132:135], v[252:255], v[184:199]
    ds_read_b128 v[128:131], v17 offset:0
    ds_read_b128 v[132:135], v17 offset:4096
    s_add_u32 s14, s96, 20480
    buffer_load_dwordx4 v[240:243], v11, s[76:79], s14 offen offset:0 sc1
    buffer_load_dwordx4 v[244:247], v11, s[76:79], s14 offen offset:1024 sc1
    s_add_u32 m0, s90, 38912
    s_add_u32 s17, s86, 49280
    buffer_load_dwordx4 v4, s[68:71], s17 offen offset:0  lds
    buffer_load_dwordx4 v5, s[68:71], s17 offen offset:1024  lds
    v_mfma_f32_32x32x16_bf16 v[136:151], v[24:27], v[200:203], v[136:151]
    v_mfma_f32_32x32x16_bf16 v[168:183], v[24:27], v[204:207], v[168:183]
    v_mfma_f32_32x32x16_bf16 v[152:167], v[28:31], v[200:203], v[152:167]
    v_mfma_f32_32x32x16_bf16 v[184:199], v[28:31], v[204:207], v[184:199]
    ds_read_b128 v[24:27], v18 offset:0
    ds_read_b128 v[28:31], v18 offset:4096
    s_add_u32 s14, s84, 16384
    buffer_load_dwordx4 v[248:251], v11, s[76:79], s14 offen offset:0 sc1
    buffer_load_dwordx4 v[252:255], v11, s[76:79], s14 offen offset:1024 sc1
    s_add_u32 m0, s90, 65536
    s_add_u32 s17, s86, 128
    buffer_load_dwordx4 v4, s[72:75], s17 offen offset:0  lds
    buffer_load_dwordx4 v5, s[72:75], s17 offen offset:1024  lds
    v_mfma_f32_32x32x16_bf16 v[136:151], v[32:35], v[208:211], v[136:151]
    v_mfma_f32_32x32x16_bf16 v[168:183], v[32:35], v[212:215], v[168:183]
    v_mfma_f32_32x32x16_bf16 v[152:167], v[36:39], v[208:211], v[152:167]
    v_mfma_f32_32x32x16_bf16 v[184:199], v[36:39], v[212:215], v[184:199]
    ds_read_b128 v[32:35], v19 offset:0
    ds_read_b128 v[36:39], v19 offset:4096
    s_add_u32 s14, s84, 20480
    buffer_load_dwordx4 v[200:203], v11, s[76:79], s14 offen offset:0 sc1
    buffer_load_dwordx4 v[204:207], v11, s[76:79], s14 offen offset:1024 sc1
    s_add_u32 m0, s90, 67584
    s_add_u32 s17, s86, 16512
    buffer_load_dwordx4 v4, s[72:75], s17 offen offset:0  lds
    buffer_load_dwordx4 v5, s[72:75], s17 offen offset:1024  lds
    s_waitcnt vmcnt(22)
    v_mfma_f32_32x32x16_bf16 v[136:151], v[40:43], v[216:219], v[136:151]
    v_mfma_f32_32x32x16_bf16 v[168:183], v[40:43], v[220:223], v[168:183]
    v_mfma_f32_32x32x16_bf16 v[152:167], v[44:47], v[216:219], v[152:167]
    v_mfma_f32_32x32x16_bf16 v[184:199], v[44:47], v[220:223], v[184:199]
    s_waitcnt vmcnt(8)
    ds_read_b128 v[40:43], v16 offset:32768
    ds_read_b128 v[44:47], v16 offset:36864
    s_mov_b32 s15, 200000
L_L_W3:
    s_waitcnt lgkmcnt(0)
    s_xor_b64 s[28:29], s[28:29], s[26:27]
    s_xor_b64 s[30:31], s[30:31], s[26:27]
    s_xor_b64 s[32:33], s[32:33], s[26:27]
    s_xor_b64 s[34:35], s[34:35], s[26:27]
    s_or_b64 s[28:29], s[28:29], s[30:31]
    s_or_b64 s[32:33], s[32:33], s[34:35]
    s_or_b64 s[28:29], s[28:29], s[32:33]
    s_cbranch_scc0 L_L_Q3
    s_sub_u32 s15, s15, 1
    s_cbranch_scc1 L_L_Q3
    s_load_dwordx8 s[28:35], s[24:25], 384 glc
    s_branch L_L_W3
L_L_Q3:
    s_add_u32 s14, s85, 0
    buffer_load_dwordx4 v[208:211], v11, s[76:79], s14 offen offset:0 sc1
    buffer_load_dwordx4 v[212:215], v11, s[76:79], s14 offen offset:1024 sc1
    s_add_u32 m0, s90, 69632
    s_add_u32 s17, s86, 32896
    buffer_load_dwordx4 v4, s[72:75], s17 offen offset:0  lds
    buffer_load_dwordx4 v5, s[72:75], s17 offen offset:1024  lds
    v_mfma_f32_32x32x16_bf16 v[136:151], v[48:51], v[224:227], v[136:151]
    v_mfma_f32_32x32x16_bf16 v[168:183], v[48:51], v[228:231], v[168:183]
    v_mfma_f32_32x32x16_bf16 v[152:167], v[52:55], v[224:227], v[152:167]
    v_mfma_f32_32x32x16_bf16 v[184:199], v[52:55], v[228:231], v[184:199]
    ds_read_b128 v[48:51], v17 offset:32768
    ds_read_b128 v[52:55], v17 offset:36864
    s_add_u32 s14, s85, 4096
    buffer_load_dwordx4 v[216:219], v11, s[76:79], s14 offen offset:0 sc1
    buffer_load_dwordx4 v[220:223], v11, s[76:79], s14 offen offset:1024 sc1
    s_add_u32 m0, s90, 71680
    s_add_u32 s17, s86, 49280
    buffer_load_dwordx4 v4, s[72:75], s17 offen offset:0  lds
    buffer_load_dwordx4 v5, s[72:75], s17 offen offset:1024  lds
    v_mfma_f32_32x32x16_bf16 v[136:151], v[56:59], v[232:235], v[136:151]
    v_mfma_f32_32x32x16_bf16 v[168:183], v[56:59], v[236:239], v[168:183]
    v_mfma_f32_32x32x16_bf16 v[152:167], v[60:63], v[232:235], v[152:167]
    v_mfma_f32_32x32x16_bf16 v[184:199], v[60:63], v[236:239], v[184:199]
    ds_read_b128 v[56:59], v18 offset:32768
    ds_read_b128 v[60:63], v18 offset:36864
    s_add_u32 s14, s85, 16384
    buffer_load_dwordx4 v[224:227], v11, s[76:79], s14 offen offset:0 sc1
    buffer_load_dwordx4 v[228:231], v11, s[76:79], s14 offen offset:1024 sc1
    v_mfma_f32_32x32x16_bf16 v[136:151], v[64:67], v[240:243], v[136:151]
    v_mfma_f32_32x32x16_bf16 v[168:183], v[64:67], v[244:247], v[168:183]
    v_mfma_f32_32x32x16_bf16 v[152:167], v[68:71], v[240:243], v[152:167]
    v_mfma_f32_32x32x16_bf16 v[184:199], v[68:71], v[244:247], v[184:199]
    ds_read_b128 v[64:67], v19 offset:32768
    ds_read_b128 v[68:71], v19 offset:36864
    s_add_u32 s14, s85, 20480
    buffer_load_dwordx4 v[232:235], v11, s[76:79], s14 offen offset:0 sc1
    buffer_load_dwordx4 v[236:239], v11, s[76:79], s14 offen offset:1024 sc1
    s_waitcnt vmcnt(18)
    s_cmp_eq_u32 s6, 3
    s_cbranch_scc1 L_L_SK20
    v_mfma_f32_32x32x16_bf16 v[136:151], v[72:75], v[248:251], v[136:151]
    v_mfma_f32_32x32x16_bf16 v[168:183], v[72:75], v[252:255], v[168:183]
    v_mfma_f32_32x32x16_bf16 v[152:167], v[76:79], v[248:251], v[152:167]
    v_mfma_f32_32x32x16_bf16 v[184:199], v[76:79], v[252:255], v[184:199]
L_L_SK20:
    s_waitcnt vmcnt(4)
    ds_read_b128 v[72:75], v20 offset:0
    ds_read_b128 v[76:79], v20 offset:4096
    s_add_u32 s14, s85, 8192
    buffer_load_dwordx4 v[240:243], v11, s[76:79], s14 offen offset:0 sc1
    buffer_load_dwordx4 v[244:247], v11, s[76:79], s14 offen offset:1024 sc1
    s_cmp_eq_u32 s6, 3
    s_cbranch_scc1 L_L_SK21
    v_mfma_f32_32x32x16_bf16 v[136:151], v[80:83], v[200:203], v[136:151]
    v_mfma_f32_32x32x16_bf16 v[168:183], v[80:83], v[204:207], v[168:183]
    v_mfma_f32_32x32x16_bf16 v[152:167], v[84:87], v[200:203], v[152:167]
    v_mfma_f32_32x32x16_bf16 v[184:199], v[84:87], v[204:207], v[184:199]
L_L_SK21:
    ds_read_b128 v[80:83], v21 offset:0
    ds_read_b128 v[84:87], v21 offset:4096
    s_add_u32 s14, s85, 12288
    buffer_load_dwordx4 v[248:251], v11, s[76:79], s14 offen offset:0 sc1
    buffer_load_dwordx4 v[252:255], v11, s[76:79], s14 offen offset:1024 sc1
    v_mfma_f32_32x32x16_bf16 v[136:151], v[88:91], v[208:211], v[136:151]
    v_mfma_f32_32x32x16_bf16 v[168:183], v[88:91], v[212:215], v[168:183]
    v_mfma_f32_32x32x16_bf16 v[152:167], v[92:95], v[208:211], v[152:167]
    v_mfma_f32_32x32x16_bf16 v[184:199], v[92:95], v[212:215], v[184:199]
    ds_read_b128 v[88:91], v22 offset:0
    ds_read_b128 v[92:95], v22 offset:4096
    s_add_u32 s14, s85, 24576
    buffer_load_dwordx4 v[200:203], v11, s[76:79], s14 offen offset:0 sc1
    buffer_load_dwordx4 v[204:207], v11, s[76:79], s14 offen offset:1024 sc1
    v_mfma_f32_32x32x16_bf16 v[136:151], v[96:99], v[216:219], v[136:151]
    v_mfma_f32_32x32x16_bf16 v[168:183], v[96:99], v[220:223], v[168:183]
    v_mfma_f32_32x32x16_bf16 v[152:167], v[100:103], v[216:219], v[152:167]
    v_mfma_f32_32x32x16_bf16 v[184:199], v[100:103], v[220:223], v[184:199]
    ds_read_b128 v[96:99], v23 offset:0
    ds_read_b128 v[100:103], v23 offset:4096
    s_add_u32 s14, s85, 28672
    buffer_load_dwordx4 v[208:211], v11, s[76:79], s14 offen offset:0 sc1
    buffer_load_dwordx4 v[212:215], v11, s[76:79], s14 offen offset:1024 sc1
    s_waitcnt vmcnt(10)
    v_mfma_f32_32x32x16_bf16 v[136:151], v[104:107], v[224:227], v[136:151]
    v_mfma_f32_32x32x16_bf16 v[168:183], v[104:107], v[228:231], v[168:183]
    v_mfma_f32_32x32x16_bf16 v[152:167], v[108:111], v[224:227], v[152:167]
    v_mfma_f32_32x32x16_bf16 v[184:199], v[108:111], v[228:231], v[184:199]
    s_add_u32 s14, s85, 32768
    buffer_load_dwordx4 v[216:219], v11, s[76:79], s14 offen offset:0 sc1
    buffer_load_dwordx4 v[220:223], v11, s[76:79], s14 offen offset:1024 sc1
    s_waitcnt vmcnt(10)
    v_mfma_f32_32x32x16_bf16 v[136:151], v[112:115], v[232:235], v[136:151]
    v_mfma_f32_32x32x16_bf16 v[168:183], v[112:115], v[236:239], v[168:183]
    v_mfma_f32_32x32x16_bf16 v[152:167], v[116:119], v[232:235], v[152:167]
    v_mfma_f32_32x32x16_bf16 v[184:199], v[116:119], v[236:239], v[184:199]
    s_add_u32 s14, s85, 36864
    buffer_load_dwordx4 v[224:227], v11, s[76:79], s14 offen offset:0 sc1
    buffer_load_dwordx4 v[228:231], v11, s[76:79], s14 offen offset:1024 sc1
    s_waitcnt vmcnt(10)
    v_mfma_f32_32x32x16_bf16 v[136:151], v[120:123], v[240:243], v[136:151]
    v_mfma_f32_32x32x16_bf16 v[168:183], v[120:123], v[244:247], v[168:183]
    v_mfma_f32_32x32x16_bf16 v[152:167], v[124:127], v[240:243], v[152:167]
    v_mfma_f32_32x32x16_bf16 v[184:199], v[124:127], v[244:247], v[184:199]
    s_add_u32 s14, s85, 49152
    buffer_load_dwordx4 v[232:235], v11, s[76:79], s14 offen offset:0 sc1
    buffer_load_dwordx4 v[236:239], v11, s[76:79], s14 offen offset:1024 sc1
    s_waitcnt vmcnt(10)
    v_mfma_f32_32x32x16_bf16 v[136:151], v[128:131], v[248:251], v[136:151]
    v_mfma_f32_32x32x16_bf16 v[168:183], v[128:131], v[252:255], v[168:183]
    v_mfma_f32_32x32x16_bf16 v[152:167], v[132:135], v[248:251], v[152:167]
    v_mfma_f32_32x32x16_bf16 v[184:199], v[132:135], v[252:255], v[184:199]
    s_add_u32 s14, s85, 53248
    buffer_load_dwordx4 v[240:243], v11, s[76:79], s14 offen offset:0 sc1
    buffer_load_dwordx4 v[244:247], v11, s[76:79], s14 offen offset:1024 sc1
    s_waitcnt vmcnt(10)
    v_mfma_f32_32x32x16_bf16 v[136:151], v[24:27], v[200:203], v[136:151]
    v_mfma_f32_32x32x16_bf16 v[168:183], v[24:27], v[204:207], v[168:183]
    v_mfma_f32_32x32x16_bf16 v[152:167], v[28:31], v[200:203], v[152:167]
    v_mfma_f32_32x32x16_bf16 v[184:199], v[28:31], v[204:207], v[184:199]
    s_add_u32 s14, s85, 40960
    buffer_load_dwordx4 v[248:251], v11, s[76:79], s14 offen offset:0 sc1
    buffer_load_dwordx4 v[252:255], v11, s[76:79], s14 offen offset:1024 sc1
    s_waitcnt vmcnt(10)
    v_mfma_f32_32x32x16_bf16 v[136:151], v[32:35], v[208:211], v[136:151]
    v_mfma_f32_32x32x16_bf16 v[168:183], v[32:35], v[212:215], v[168:183]
    v_mfma_f32_32x32x16_bf16 v[152:167], v[36:39], v[208:211], v[152:167]
    v_mfma_f32_32x32x16_bf16 v[184:199], v[36:39], v[212:215], v[184:199]
    s_add_u32 s14, s85, 45056
    buffer_load_dwordx4 v[200:203], v11, s[76:79], s14 offen offset:0 sc1
    buffer_load_dwordx4 v[204:207], v11, s[76:79], s14 offen offset:1024 sc1
    s_waitcnt vmcnt(10)
    v_mfma_f32_32x32x16_bf16 v[136:151], v[40:43], v[216:219], v[136:151]
    v_mfma_f32_32x32x16_bf16 v[168:183], v[40:43], v[220:223], v[168:183]
    v_mfma_f32_32x32x16_bf16 v[152:167], v[44:47], v[216:219], v[152:167]
    v_mfma_f32_32x32x16_bf16 v[184:199], v[44:47], v[220:223], v[184:199]
    s_add_u32 s14, s85, 57344
    buffer_load_dwordx4 v[208:211], v11, s[76:79], s14 offen offset:0 sc1
    buffer_load_dwordx4 v[212:215], v11, s[76:79], s14 offen offset:1024 sc1
    s_waitcnt vmcnt(10)
    s_waitcnt lgkmcnt(12)
    v_mfma_f32_32x32x16_bf16 v[136:151], v[48:51], v[224:227], v[136:151]
    v_mfma_f32_32x32x16_bf16 v[168:183], v[48:51], v[228:231], v[168:183]
    v_mfma_f32_32x32x16_bf16 v[152:167], v[52:55], v[224:227], v[152:167]
    v_mfma_f32_32x32x16_bf16 v[184:199], v[52:55], v[228:231], v[184:199]
    s_add_u32 s14, s85, 61440
    buffer_load_dwordx4 v[216:219], v11, s[76:79], s14 offen offset:0 sc1
    buffer_load_dwordx4 v[220:223], v11, s[76:79], s14 offen offset:1024 sc1
    s_waitcnt vmcnt(10)
    s_waitcnt lgkmcnt(10)
    v_mfma_f32_32x32x16_bf16 v[136:151], v[56:59], v[232:235], v[136:151]
    v_mfma_f32_32x32x16_bf16 v[168:183], v[56:59], v[236:239], v[168:183]
    v_mfma_f32_32x32x16_bf16 v[152:167], v[60:63], v[232:235], v[152:167]
    v_mfma_f32_32x32x16_bf16 v[184:199], v[60:63], v[236:239], v[184:199]
    s_waitcnt vmcnt(8)
    s_waitcnt lgkmcnt(8)
    v_mfma_f32_32x32x16_bf16 v[136:151], v[64:67], v[240:243], v[136:151]
    v_mfma_f32_32x32x16_bf16 v[168:183], v[64:67], v[244:247], v[168:183]
    v_mfma_f32_32x32x16_bf16 v[152:167], v[68:71], v[240:243], v[152:167]
    v_mfma_f32_32x32x16_bf16 v[184:199], v[68:71], v[244:247], v[184:199]
    v_and_b32 v16, 7, v1
    v_xor_b32 v16, v16, v2
    v_lshl_add_u32 v17, v1, 8, s90
    v_xor_b32 v12, 0, v16
    v_lshl_add_u32 v12, v12, 4, v17
    v_xor_b32 v13, 2, v16
    v_lshl_add_u32 v13, v13, 4, v17
    v_xor_b32 v14, 4, v16
    v_lshl_add_u32 v14, v14, 4, v17
    v_xor_b32 v15, 6, v16
    v_lshl_add_u32 v15, v15, 4, v17
    s_waitcnt lgkmcnt(0)
    s_waitcnt vmcnt(6)
    v_mfma_f32_32x32x16_bf16 v[136:151], v[72:75], v[248:251], v[136:151]
    s_waitcnt vmcnt(4)
    v_mfma_f32_32x32x16_bf16 v[136:151], v[80:83], v[200:203], v[136:151]
    s_waitcnt vmcnt(2)
    v_mfma_f32_32x32x16_bf16 v[136:151], v[88:91], v[208:211], v[136:151]
    s_waitcnt vmcnt(0)
    v_mfma_f32_32x32x16_bf16 v[136:151], v[96:99], v[216:219], v[136:151]
    v_mfma_f32_32x32x16_bf16 v[152:167], v[76:79], v[248:251], v[152:167]
    v_mfma_f32_32x32x16_bf16 v[152:167], v[84:87], v[200:203], v[152:167]
    v_mfma_f32_32x32x16_bf16 v[152:167], v[92:95], v[208:211], v[152:167]
    ds_write_b128 v12, v[136:139] offset:0
    v_mfma_f32_32x32x16_bf16 v[152:167], v[100:103], v[216:219], v[152:167]
    ds_write_b128 v13, v[140:143] offset:0
    v_mfma_f32_32x32x16_bf16 v[168:183], v[72:75], v[252:255], v[168:183]
    ds_write_b128 v14, v[144:147] offset:0
    v_mfma_f32_32x32x16_bf16 v[168:183], v[80:83], v[204:207], v[168:183]
    ds_write_b128 v15, v[148:151] offset:0
    v_mfma_f32_32x32x16_bf16 v[168:183], v[88:91], v[212:215], v[168:183]
    ds_write_b128 v12, v[152:155] offset:128
    v_mfma_f32_32x32x16_bf16 v[168:183], v[96:99], v[220:223], v[168:183]
    ds_write_b128 v13, v[156:159] offset:128
    v_mfma_f32_32x32x16_bf16 v[184:199], v[76:79], v[252:255], v[184:199]
    ds_write_b128 v14, v[160:163] offset:128
    v_mfma_f32_32x32x16_bf16 v[184:199], v[84:87], v[204:207], v[184:199]
    ds_write_b128 v15, v[164:167] offset:128
    v_mfma_f32_32x32x16_bf16 v[184:199], v[92:95], v[212:215], v[184:199]
    ds_write_b128 v12, v[168:171] offset:32768
    v_mfma_f32_32x32x16_bf16 v[184:199], v[100:103], v[220:223], v[184:199]
    ds_write_b128 v13, v[172:175] offset:32768
    s_waitcnt lgkmcnt(2)
    s_barrier
    ds_write_b128 v14, v[176:179] offset:32768
    ds_write_b128 v15, v[180:183] offset:32768
    s_nop 7
    ds_write_b128 v12, v[184:187] offset:32896
    ds_write_b128 v13, v[188:191] offset:32896
    ds_write_b128 v14, v[192:195] offset:32896
    ds_write_b128 v15, v[196:199] offset:32896
    s_waitcnt lgkmcnt(0)
    s_barrier
L_EXIT:
    s_endpgm
L_COMPUTE:
    s_bfe_u32 s7, s5, 0x10002
    s_lshr_b32 s8, s5, 3
    s_lshl_b32 s8, s8, 2
    s_and_b32 s14, s5, 3
    s_add_u32 s8, s8, s14
    v_and_b32 v1, 31, v0
    v_lshrrev_b32 v2, 5, v0
    s_lshl_b32 s13, s4, 4
    s_add_u32 s13, s13, s5
    s_lshl_b32 s13, s13, 2
    s_add_u32 s13, s13, s3
    s_lshl_b32 s90, s13, 5
    s_lshl_b32 s91, s13, 11
    v_lshlrev_b32 v4, 4, v0
    s_cmp_lg_u32 s3, 0
    s_cbranch_scc1 L_C_NOPF
    s_getpc_b64 s[92:93]
L_PC:
    s_lshr_b32 s13, s2, 3
    v_and_b32 v210, 7, v0
    v_lshl_add_u32 v210, s13, 3, v210
    v_lshlrev_b32 v210, 7, v210
    v_min_u32 v210, L_CODE_END-gated_mix__ssm_conv_s5__mixer_channel_mlp__prompt_kernel-4, v210
    s_sub_u32 s92, s92, L_PC-gated_mix__ssm_conv_s5__mixer_channel_mlp__prompt_kernel
    s_subb_u32 s93, s93, 0
    v_mov_b32 v211, s93
    v_add_co_u32 v210, vcc, s92, v210
    s_nop 1
    v_addc_co_u32 v211, vcc, 0, v211, vcc
    global_load_dword v215, v[210:211], off
L_C_NOPF:
    s_waitcnt lgkmcnt(0)
    s_mov_b32 s52, s16
    s_mov_b32 s53, s17
    s_mov_b32 s54, 2097152
    s_mov_b32 s55, 0x20000
    s_and_b32 s14, s5, 3
    s_lshr_b32 s13, s5, 2
    s_mul_i32 s13, s13, 11
    s_mul_i32 s9, s14, 3
    s_add_u32 s9, s9, s13
    s_min_u32 s9, s9, 41
    s_cmp_eq_u32 s14, 3
    s_cselect_b32 s10, 2, 3
    s_cmp_eq_u32 s5, 14
    s_cselect_b32 s10, 2, s10
    s_mul_i32 s13, s4, 614400
    s_lshl_b32 s14, s4, 18
    s_lshl_b32 s92, s5, 6
    s_lshl_b32 s93, s8, 7
    s_lshl_b32 s98, s9, 6
    s_add_u32 s99, s98, 124
    s_add_u32 s15, s13, 614396
    s_cmp_lg_u32 s3, 0
    s_cbranch_scc1 L_C_TL0
    s_load_dword s94, s[22:23], 0
    s_load_dword s95, s[40:41], 0
    s_load_dword s96, s[18:19], s92
    s_load_dword s97, s[38:39], s98
    s_load_dword s94, s[38:39], s99
    s_branch L_C_TL3
L_C_TL0:
    s_cmp_lg_u32 s3, 1
    s_cbranch_scc1 L_C_TL1
    s_load_dword s94, s[24:25], 0
    s_load_dword s95, s[26:27], 0
    s_load_dword s96, s[20:21], s92
    s_load_dword s97, s[42:43], s93
    s_branch L_C_TL3
L_C_TL1:
    s_cmp_lg_u32 s3, 2
    s_cbranch_scc1 L_C_TL2
    s_load_dword s94, s[36:37], 0
    s_load_dword s95, s[28:29], 0
    s_load_dword s96, s[30:31], s92
    s_load_dword s97, s[32:33], s93
    s_branch L_C_TL3
L_C_TL2:
    s_load_dword s94, s[44:45], 0
    s_load_dword s95, s[50:51], s13
    s_load_dword s96, s[50:51], s15
    s_load_dword s97, s[46:47], s14
L_C_TL3:
    s_mov_b32 s76, s50
    s_mov_b32 s77, s51
    s_mov_b32 s78, 10944512
    s_mov_b32 s79, 0x20000
    v_bfe_u32 v208, v1, 1, 3
    s_mul_i32 s15, s3, 7168
    v_lshl_add_u32 v209, v1, 7, s15
    v_lshrrev_b32 v212, 4, v1
    v_mul_u32_u24 v212, 5120, v212
    v_lshl_add_u32 v212, v1, 7, v212
    v_bfe_u32 v122, v0, 2, 2
    v_lshl_add_u32 v122, v2, 3, v122
    v_lshlrev_b32 v122, 6, v122
    v_bfe_u32 v211, v0, 4, 1
    v_lshl_add_u32 v122, v211, 5, v122
    v_and_b32 v211, 3, v0
    v_lshl_add_u32 v122, v211, 3, v122
    v_add_u32 v211, 0, v2
    v_xor_b32 v211, v211, v208
    v_lshl_add_u32 v12, v211, 4, v212
    v_lshl_add_u32 v8, v211, 4, v209
    v_add_u32 v211, 2, v2
    v_xor_b32 v211, v211, v208
    v_lshl_add_u32 v13, v211, 4, v212
    v_lshl_add_u32 v9, v211, 4, v209
    v_add_u32 v211, 4, v2
    v_xor_b32 v211, v211, v208
    v_lshl_add_u32 v14, v211, 4, v212
    v_lshl_add_u32 v10, v211, 4, v209
    v_add_u32 v211, 6, v2
    v_xor_b32 v211, v211, v208
    v_lshl_add_u32 v15, v211, 4, v212
    v_lshl_add_u32 v11, v211, 4, v209
    v_mov_b32 v126, 0x3f803f80
    v_lshlrev_b32 v6, 4, v2
    v_add_u32 v6, 151552, v6
    v_mov_b32 v5, 2146435072
    v_cmp_eq_u32 vcc, 0, v0
    s_mov_b32 s86, 0xbdd2d3e8
    s_mov_b32 s87, 0xc0135761
    v_cndmask_b32 v5, v5, v0, vcc
    s_lshl_b32 s13, s3, 10
    s_add_u32 s13, s13, 147456
    v_lshl_add_u32 v123, v2, 9, s13
    v_lshl_add_u32 v123, v1, 4, v123
    v_bfe_u32 v125, v1, 2, 1
    v_lshlrev_b32 v125, 4, v125
    v_and_b32 v201, 1, v1
    v_lshl_add_u32 v125, v201, 3, v125
    v_lshrrev_b32 v201, 3, v1
    v_lshl_add_u32 v125, v201, 1, v125
    v_bfe_u32 v201, v1, 1, 1
    v_add_u32 v125, v125, v201
    v_lshlrev_b32 v125, 4, v125
    s_mul_i32 s13, s3, 2560
    s_add_u32 s13, s13, 153088
    v_add_u32 v124, s13, v125
    s_mul_i32 s88, s4, 614400
    s_lshl_b32 s13, s3, 10
    s_add_u32 s88, s88, s13
    s_lshl_b32 s85, s9, 13
    s_add_u32 s85, s85, s88
    s_mov_b32 s84, 0
    s_lshr_b32 s13, s5, 2
    s_lshl_b32 s14, s4, 2
    s_add_u32 s13, s13, s14
    s_lshl_b32 s13, s13, 1
    s_lshr_b32 s14, s3, 1
    s_add_u32 s13, s13, s14
    s_lshl_b32 s89, s13, 9
    s_and_b32 s13, s5, 3
    s_lshl_b32 s13, s13, 1
    s_and_b32 s14, s3, 1
    s_add_u32 s13, s13, s14
    s_lshl_b32 s13, s13, 2
    s_add_u32 s89, s89, s13
    s_add_u32 s89, s89, 10747904
    v_min_u32 v118, 23, v0
    v_lshlrev_b32 v118, 2, v118
    v_add_u32 v118, 163328, v118
    v_mov_b32 v116, 0
    ds_write_b32 v118, v116
    ds_write_b32 v118, v116 offset:288
    buffer_load_dwordx4 v[192:195], v4, s[52:55], s91 offen
    buffer_load_dwordx4 v[196:199], v4, s[52:55], s91 offen offset:1024
    global_load_dwordx4 v[248:251], v4, s[44:45]
    s_lshl_b32 s13, s4, 7
    s_lshl_b32 s14, s5, 7
    s_add_u32 s14, s14, 4096
    s_sub_u32 s14, s14, s13
    v_mul_lo_u32 v7, s14, v2
    s_add_u32 s13, s13, 10878976
    buffer_load_dword v7, v7, s[76:79], s13 offen sc1
    s_waitcnt lgkmcnt(0)
L_C_B0:
    s_barrier
    ds_read_b128 v[128:131], v8 offset:0
    ds_read_b128 v[64:67], v12 offset:4096
    ds_read_b128 v[68:71], v12 offset:18432
    ds_read_b64_tr_b16 v[72:73], v122 offset:6144
    ds_read_b64_tr_b16 v[74:75], v122 offset:6400
    s_waitcnt lgkmcnt(3)
    v_mfma_f32_32x32x16_bf16 v[16:31], v[128:131], v[64:67], 0
    ds_read_b128 v[132:135], v9 offset:0
    ds_read_b128 v[76:79], v13 offset:4096
    s_waitcnt lgkmcnt(4)
    v_mfma_f32_32x32x16_bf16 v[32:47], v[128:131], v[68:71], 0
    ds_read_b128 v[80:83], v13 offset:18432
    ds_read_b64_tr_b16 v[84:85], v122 offset:13312
    s_waitcnt lgkmcnt(4)
    v_mfma_f32_32x32x16_bf16 v[48:63], v[72:75], v[128:131], 0
    ds_read_b64_tr_b16 v[86:87], v122 offset:13568
    s_waitcnt lgkmcnt(3)
    v_mfma_f32_32x32x16_bf16 v[16:31], v[132:135], v[76:79], v[16:31]
    ds_read_b128 v[136:139], v10 offset:0
    ds_read_b128 v[64:67], v14 offset:4096
    s_waitcnt lgkmcnt(4)
    v_mfma_f32_32x32x16_bf16 v[32:47], v[132:135], v[80:83], v[32:47]
    ds_read_b128 v[68:71], v14 offset:18432
    ds_read_b64_tr_b16 v[72:73], v122 offset:20480
    s_waitcnt lgkmcnt(4)
    v_mfma_f32_32x32x16_bf16 v[48:63], v[84:87], v[132:135], v[48:63]
    ds_read_b64_tr_b16 v[74:75], v122 offset:20736
    s_waitcnt lgkmcnt(3)
    v_mfma_f32_32x32x16_bf16 v[16:31], v[136:139], v[64:67], v[16:31]
    ds_read_b128 v[140:143], v11 offset:0
    ds_read_b128 v[76:79], v15 offset:4096
    s_waitcnt lgkmcnt(4)
    v_mfma_f32_32x32x16_bf16 v[32:47], v[136:139], v[68:71], v[32:47]
    ds_read_b128 v[80:83], v15 offset:18432
    ds_read_b64_tr_b16 v[84:85], v122 offset:27648
    s_waitcnt lgkmcnt(4)
    v_mfma_f32_32x32x16_bf16 v[48:63], v[72:75], v[136:139], v[48:63]
    ds_read_b64_tr_b16 v[86:87], v122 offset:27904
    s_waitcnt lgkmcnt(3)
    v_mfma_f32_32x32x16_bf16 v[16:31], v[140:143], v[76:79], v[16:31]
    s_waitcnt lgkmcnt(0)
    v_mfma_f32_32x32x16_bf16 v[32:47], v[140:143], v[80:83], v[32:47]
    v_mfma_f32_32x32x16_bf16 v[48:63], v[84:87], v[140:143], v[48:63]
    s_waitcnt vmcnt(0)
    v_readlane_b32 s11, v7, 0
    v_readlane_b32 s12, v7, 32
    s_mul_i32 s11, s11, 0x9e3779b1
    s_add_u32 s11, s11, 0x7f4a7c15
    s_mul_i32 s12, s12, 0x9e3779b1
    s_add_u32 s12, s12, 0x7f4a7c15
    v_mov_b32 v208, 0
    v_mov_b32 v209, 0
    v_mov_b32 v210, 0
    v_mov_b32 v211, 0
    v_mov_b32 v212, 0
    v_mov_b32 v213, 0
    v_lshlrev_b32 v232, 16, v248
    v_and_b32 v233, 0xffff0000, v248
    v_lshlrev_b32 v234, 16, v249
    v_and_b32 v235, 0xffff0000, v249
    v_lshlrev_b32 v236, 16, v250
    v_and_b32 v237, 0xffff0000, v250
    v_lshlrev_b32 v238, 16, v251
    v_and_b32 v239, 0xffff0000, v251
    v_lshlrev_b32 v216, 16, v192
    v_and_b32 v217, 0xffff0000, v192
    v_lshlrev_b32 v218, 16, v193
    v_and_b32 v219, 0xffff0000, v193
    v_lshlrev_b32 v220, 16, v194
    v_and_b32 v221, 0xffff0000, v194
    v_lshlrev_b32 v222, 16, v195
    v_and_b32 v223, 0xffff0000, v195
    v_lshlrev_b32 v224, 16, v196
    v_and_b32 v225, 0xffff0000, v196
    v_lshlrev_b32 v226, 16, v197
    v_and_b32 v227, 0xffff0000, v197
    v_lshlrev_b32 v228, 16, v198
    v_and_b32 v229, 0xffff0000, v198
    v_lshlrev_b32 v230, 16, v199
    v_and_b32 v231, 0xffff0000, v199
    v_pk_mul_f32 v[216:217], v[216:217], v[232:233]
    v_pk_mul_f32 v[218:219], v[218:219], v[234:235]
    v_pk_mul_f32 v[220:221], v[220:221], v[236:237]
    v_pk_mul_f32 v[222:223], v[222:223], v[238:239]
    v_pk_mul_f32 v[224:225], v[224:225], v[232:233]
    v_pk_mul_f32 v[226:227], v[226:227], v[234:235]
    v_pk_mul_f32 v[228:229], v[228:229], v[236:237]
    v_pk_mul_f32 v[230:231], v[230:231], v[238:239]
    v_cvt_pk_bf16_f32 v240, v216, v217
    v_cvt_pk_bf16_f32 v241, v218, v219
    v_cvt_pk_bf16_f32 v242, v220, v221
    v_cvt_pk_bf16_f32 v243, v222, v223
    v_cvt_pk_bf16_f32 v244, v224, v225
    v_cvt_pk_bf16_f32 v245, v226, v227
    v_cvt_pk_bf16_f32 v246, v228, v229
    v_cvt_pk_bf16_f32 v247, v230, v231
    v_dot2_f32_bf16 v208, v192, v126, v208
    v_dot2_f32_bf16 v209, v192, v192, v209
    v_dot2_f32_bf16 v210, v240, v126, v210
    v_dot2_f32_bf16 v211, v196, v126, v211
    v_dot2_f32_bf16 v212, v196, v196, v212
    v_dot2_f32_bf16 v213, v244, v126, v213
    v_dot2_f32_bf16 v208, v193, v126, v208
    v_dot2_f32_bf16 v209, v193, v193, v209
    v_dot2_f32_bf16 v210, v241, v126, v210
    v_dot2_f32_bf16 v211, v197, v126, v211
    v_dot2_f32_bf16 v212, v197, v197, v212
    v_dot2_f32_bf16 v213, v245, v126, v213
    v_dot2_f32_bf16 v208, v194, v126, v208
    v_dot2_f32_bf16 v209, v194, v194, v209
    v_dot2_f32_bf16 v210, v242, v126, v210
    v_dot2_f32_bf16 v211, v198, v126, v211
    v_dot2_f32_bf16 v212, v198, v198, v212
    v_dot2_f32_bf16 v213, v246, v126, v213
    v_dot2_f32_bf16 v208, v195, v126, v208
    v_dot2_f32_bf16 v209, v195, v195, v209
    v_dot2_f32_bf16 v210, v243, v126, v210
    v_dot2_f32_bf16 v211, v199, v126, v211
    v_dot2_f32_bf16 v212, v199, v199, v212
    v_dot2_f32_bf16 v213, v247, v126, v213
    s_nop 1
    v_permlane32_swap_b32 v208, v211
    v_permlane32_swap_b32 v209, v212
    v_permlane32_swap_b32 v210, v213
    v_add_f32 v208, v208, v211
    v_add_f32 v209, v209, v212
    v_add_f32 v210, v210, v213
    v_add_f32_dpp v208, v208, v208 quad_perm:[1,0,3,2] row_mask:0xf bank_mask:0xf
    v_add_f32_dpp v209, v209, v209 quad_perm:[1,0,3,2] row_mask:0xf bank_mask:0xf
    v_add_f32_dpp v210, v210, v210 quad_perm:[1,0,3,2] row_mask:0xf bank_mask:0xf
    v_add_f32_dpp v208, v208, v208 quad_perm:[2,3,0,1] row_mask:0xf bank_mask:0xf
    v_add_f32_dpp v209, v209, v209 quad_perm:[2,3,0,1] row_mask:0xf bank_mask:0xf
    v_add_f32_dpp v210, v210, v210 quad_perm:[2,3,0,1] row_mask:0xf bank_mask:0xf
    v_add_f32_dpp v208, v208, v208 row_half_mirror row_mask:0xf bank_mask:0xf
    v_add_f32_dpp v209, v209, v209 row_half_mirror row_mask:0xf bank_mask:0xf
    v_add_f32_dpp v210, v210, v210 row_half_mirror row_mask:0xf bank_mask:0xf
    v_add_f32_dpp v208, v208, v208 row_mirror row_mask:0xf bank_mask:0xf
    v_add_f32_dpp v209, v209, v209 row_mirror row_mask:0xf bank_mask:0xf
    v_add_f32_dpp v210, v210, v210 row_mirror row_mask:0xf bank_mask:0xf
    v_mov_b32 v240, v208
    v_mov_b32 v241, v209
    v_mov_b32 v242, v210
    v_permlane16_swap_b32 v208, v240
    v_permlane16_swap_b32 v209, v241
    v_permlane16_swap_b32 v210, v242
    v_add_f32 v208, v208, v240
    v_add_f32 v209, v209, v241
    v_add_f32 v210, v210, v242
    v_mul_f32 v208, 0x3b000000, v208
    v_mul_f32 v209, 0x3b000000, v209
    v_cvt_pk_bf16_f32 v210, v210, v210
    v_and_b32 v210, 0xffff0000, v210
    v_fma_f32 v209, -v208, v208, v209
    v_mul_f32 v210, 0xbfb8aa3b, v210
    v_max_f32 v209, 0, v209
    v_exp_f32 v210, v210
    v_cvt_pk_bf16_f32 v209, v209, v209
    v_and_b32 v209, 0xffff0000, v209
    v_cvt_pk_bf16_f32 v100, v208, v208
    v_and_b32 v100, 0xffff0000, v100
    v_add_f32 v209, 0x3727c5ac, v209
    v_add_f32 v210, 1.0, v210
    v_cvt_pk_bf16_f32 v209, v209, v209
    v_and_b32 v209, 0xffff0000, v209
    v_rcp_f32 v210, v210
    v_sqrt_f32 v209, v209
    v_cvt_pk_bf16_f32 v102, v210, v210
    v_and_b32 v102, 0xffff0000, v102
    v_cvt_pk_bf16_f32 v209, v209, v209
    v_and_b32 v209, 0xffff0000, v209
    v_mov_b32 v103, s11
    v_rcp_f32 v101, v209
    v_mov_b32 v116, 2146435072
    v_cmp_eq_u32 vcc, 0, v1
    v_lshlrev_b32 v210, 4, v2
    s_add_u32 s90, s90, 10485760
    v_cndmask_b32 v116, v116, v210, vcc
    buffer_store_dwordx4 v[100:103], v116, s[76:79], s90 offen sc1
    v_mov_b32 v104, s11
    v_mov_b32 v105, s12
    v_mov_b32 v118, 163328
    ds_write_b64 v118, v[104:105] offset:8
    v_mov_b32 v7, s11
    s_lshl_b32 s13, s4, 2
    s_add_u32 s13, s13, s3
    s_lshl_b32 s13, s13, 9
    s_add_u32 s90, s13, 10485760
    s_waitcnt lgkmcnt(0)
    s_barrier
    ds_read_b128 v[144:147], v8 offset:28672
    ds_read_b128 v[64:67], v12 offset:32768
    ds_read_b128 v[68:71], v12 offset:47104
    ds_read_b64_tr_b16 v[72:73], v122 offset:34816
    ds_read_b64_tr_b16 v[74:75], v122 offset:35072
    s_waitcnt lgkmcnt(3)
    v_mfma_f32_32x32x16_bf16 v[16:31], v[144:147], v[64:67], v[16:31]
    ds_read_b128 v[148:151], v9 offset:28672
    ds_read_b128 v[76:79], v13 offset:32768
    s_waitcnt lgkmcnt(4)
    v_mfma_f32_32x32x16_bf16 v[32:47], v[144:147], v[68:71], v[32:47]
    ds_read_b128 v[80:83], v13 offset:47104
    ds_read_b64_tr_b16 v[84:85], v122 offset:41984
    s_waitcnt lgkmcnt(4)
    v_mfma_f32_32x32x16_bf16 v[48:63], v[72:75], v[144:147], v[48:63]
    ds_read_b64_tr_b16 v[86:87], v122 offset:42240
    s_waitcnt lgkmcnt(3)
    v_mfma_f32_32x32x16_bf16 v[16:31], v[148:151], v[76:79], v[16:31]
    ds_read_b128 v[152:155], v10 offset:28672
    ds_read_b128 v[64:67], v14 offset:32768
    s_waitcnt lgkmcnt(4)
    v_mfma_f32_32x32x16_bf16 v[32:47], v[148:151], v[80:83], v[32:47]
    ds_read_b128 v[68:71], v14 offset:47104
    ds_read_b64_tr_b16 v[72:73], v122 offset:49152
    s_waitcnt lgkmcnt(4)
    v_mfma_f32_32x32x16_bf16 v[48:63], v[84:87], v[148:151], v[48:63]
    ds_read_b64_tr_b16 v[74:75], v122 offset:49408
    s_waitcnt lgkmcnt(3)
    v_mfma_f32_32x32x16_bf16 v[16:31], v[152:155], v[64:67], v[16:31]
    ds_read_b128 v[156:159], v11 offset:28672
    ds_read_b128 v[76:79], v15 offset:32768
    s_waitcnt lgkmcnt(4)
    v_mfma_f32_32x32x16_bf16 v[32:47], v[152:155], v[68:71], v[32:47]
    ds_read_b128 v[80:83], v15 offset:47104
    ds_read_b64_tr_b16 v[84:85], v122 offset:56320
    s_waitcnt lgkmcnt(4)
    v_mfma_f32_32x32x16_bf16 v[48:63], v[72:75], v[152:155], v[48:63]
    ds_read_b64_tr_b16 v[86:87], v122 offset:56576
    s_waitcnt lgkmcnt(3)
    v_mfma_f32_32x32x16_bf16 v[16:31], v[156:159], v[76:79], v[16:31]
    s_mov_b32 s13, 57344
    v_add_u32 v8, s13, v8
    v_add_u32 v9, s13, v9
    v_add_u32 v10, s13, v10
    v_add_u32 v11, s13, v11
    v_add_u32 v12, s13, v12
    v_add_u32 v13, s13, v13
    v_add_u32 v14, s13, v14
    v_add_u32 v15, s13, v15
    v_add_u32 v122, s13, v122
    s_waitcnt lgkmcnt(0)
    s_barrier
    ds_read_b128 v[160:163], v8 offset:0
    ds_read_b128 v[64:67], v12 offset:4096
    v_mfma_f32_32x32x16_bf16 v[32:47], v[156:159], v[80:83], v[32:47]
    ds_read_b128 v[68:71], v12 offset:18432
    ds_read_b64_tr_b16 v[72:73], v122 offset:6144
    ds_read_b64_tr_b16 v[74:75], v122 offset:6400
    v_mfma_f32_32x32x16_bf16 v[48:63], v[84:87], v[156:159], v[48:63]
    s_waitcnt lgkmcnt(3)
    v_mfma_f32_32x32x16_bf16 v[16:31], v[160:163], v[64:67], v[16:31]
    ds_read_b128 v[164:167], v9 offset:0
    ds_read_b128 v[76:79], v13 offset:4096
    s_waitcnt lgkmcnt(4)
    v_mfma_f32_32x32x16_bf16 v[32:47], v[160:163], v[68:71], v[32:47]
    ds_read_b128 v[80:83], v13 offset:18432
    ds_read_b64_tr_b16 v[84:85], v122 offset:13312
    s_waitcnt lgkmcnt(4)
    v_mfma_f32_32x32x16_bf16 v[48:63], v[72:75], v[160:163], v[48:63]
    ds_read_b64_tr_b16 v[86:87], v122 offset:13568
    s_waitcnt lgkmcnt(3)
    v_mfma_f32_32x32x16_bf16 v[16:31], v[164:167], v[76:79], v[16:31]
    ds_read_b128 v[168:171], v10 offset:0
    ds_read_b128 v[64:67], v14 offset:4096
    s_waitcnt lgkmcnt(4)
    v_mfma_f32_32x32x16_bf16 v[32:47], v[164:167], v[80:83], v[32:47]
    ds_read_b128 v[68:71], v14 offset:18432
    ds_read_b64_tr_b16 v[72:73], v122 offset:20480
    s_waitcnt lgkmcnt(4)
    v_mfma_f32_32x32x16_bf16 v[48:63], v[84:87], v[164:167], v[48:63]
    ds_read_b64_tr_b16 v[74:75], v122 offset:20736
    s_waitcnt lgkmcnt(3)
    v_mfma_f32_32x32x16_bf16 v[16:31], v[168:171], v[64:67], v[16:31]
    ds_read_b128 v[172:175], v11 offset:0
    ds_read_b128 v[76:79], v15 offset:4096
    s_waitcnt lgkmcnt(4)
    v_mfma_f32_32x32x16_bf16 v[32:47], v[168:171], v[68:71], v[32:47]
    ds_read_b128 v[80:83], v15 offset:18432
    ds_read_b64_tr_b16 v[84:85], v122 offset:27648
    s_waitcnt lgkmcnt(4)
    v_mfma_f32_32x32x16_bf16 v[48:63], v[72:75], v[168:171], v[48:63]
    ds_read_b64_tr_b16 v[86:87], v122 offset:27904
    s_waitcnt lgkmcnt(3)
    v_mfma_f32_32x32x16_bf16 v[16:31], v[172:175], v[76:79], v[16:31]
    s_waitcnt lgkmcnt(0)
    s_barrier
    ds_read_b128 v[176:179], v8 offset:28672
    ds_read_b128 v[64:67], v12 offset:32768
    v_mfma_f32_32x32x16_bf16 v[32:47], v[172:175], v[80:83], v[32:47]
    ds_read_b128 v[68:71], v12 offset:47104
    ds_read_b64_tr_b16 v[72:73], v122 offset:34816
    ds_read_b64_tr_b16 v[74:75], v122 offset:35072
    v_mfma_f32_32x32x16_bf16 v[48:63], v[84:87], v[172:175], v[48:63]
    s_waitcnt lgkmcnt(3)
    v_mfma_f32_32x32x16_bf16 v[16:31], v[176:179], v[64:67], v[16:31]
    ds_read_b128 v[180:183], v9 offset:28672
    ds_read_b128 v[76:79], v13 offset:32768
    s_waitcnt lgkmcnt(4)
    v_mfma_f32_32x32x16_bf16 v[32:47], v[176:179], v[68:71], v[32:47]
    ds_read_b128 v[80:83], v13 offset:47104
    ds_read_b64_tr_b16 v[84:85], v122 offset:41984
    s_waitcnt lgkmcnt(4)
    v_mfma_f32_32x32x16_bf16 v[48:63], v[72:75], v[176:179], v[48:63]
    ds_read_b64_tr_b16 v[86:87], v122 offset:42240
    s_waitcnt lgkmcnt(3)
    v_mfma_f32_32x32x16_bf16 v[16:31], v[180:183], v[76:79], v[16:31]
    ds_read_b128 v[184:187], v10 offset:28672
    ds_read_b128 v[64:67], v14 offset:32768
    s_waitcnt lgkmcnt(4)
    v_mfma_f32_32x32x16_bf16 v[32:47], v[180:183], v[80:83], v[32:47]
    ds_read_b128 v[68:71], v14 offset:47104
    ds_read_b64_tr_b16 v[72:73], v122 offset:49152
    s_waitcnt lgkmcnt(4)
    v_mfma_f32_32x32x16_bf16 v[48:63], v[84:87], v[180:183], v[48:63]
    ds_read_b64_tr_b16 v[74:75], v122 offset:49408
    s_waitcnt lgkmcnt(3)
    v_mfma_f32_32x32x16_bf16 v[16:31], v[184:187], v[64:67], v[16:31]
    ds_read_b128 v[188:191], v11 offset:28672
    ds_read_b128 v[76:79], v15 offset:32768
    s_waitcnt lgkmcnt(4)
    v_mfma_f32_32x32x16_bf16 v[32:47], v[184:187], v[68:71], v[32:47]
    ds_read_b128 v[80:83], v15 offset:47104
    ds_read_b64_tr_b16 v[84:85], v122 offset:56320
    s_waitcnt lgkmcnt(4)
    v_mfma_f32_32x32x16_bf16 v[48:63], v[72:75], v[184:187], v[48:63]
    ds_read_b64_tr_b16 v[86:87], v122 offset:56576
    s_waitcnt lgkmcnt(3)
    v_mfma_f32_32x32x16_bf16 v[16:31], v[188:191], v[76:79], v[16:31]
    s_mov_b32 s13, 4294909952
    v_add_u32 v8, s13, v8
    v_add_u32 v9, s13, v9
    v_add_u32 v10, s13, v10
    v_add_u32 v11, s13, v11
    v_add_u32 v12, s13, v12
    v_add_u32 v13, s13, v13
    v_add_u32 v14, s13, v14
    v_add_u32 v15, s13, v15
    v_add_u32 v122, s13, v122
    s_waitcnt lgkmcnt(0)
    s_barrier
    ds_read_b128 v[192:195], v8 offset:0
    ds_read_b128 v[64:67], v12 offset:4096
    v_mfma_f32_32x32x16_bf16 v[32:47], v[188:191], v[80:83], v[32:47]
    ds_read_b128 v[68:71], v12 offset:18432
    ds_read_b64_tr_b16 v[72:73], v122 offset:6144
    ds_read_b64_tr_b16 v[74:75], v122 offset:6400
    v_mfma_f32_32x32x16_bf16 v[48:63], v[84:87], v[188:191], v[48:63]
    s_waitcnt lgkmcnt(3)
    v_mfma_f32_32x32x16_bf16 v[16:31], v[192:195], v[64:67], v[16:31]
    ds_read_b128 v[196:199], v9 offset:0
    ds_read_b128 v[76:79], v13 offset:4096
    s_waitcnt lgkmcnt(4)
    v_mfma_f32_32x32x16_bf16 v[32:47], v[192:195], v[68:71], v[32:47]
    ds_read_b128 v[80:83], v13 offset:18432
    ds_read_b64_tr_b16 v[84:85], v122 offset:13312
    s_waitcnt lgkmcnt(4)
    v_mfma_f32_32x32x16_bf16 v[48:63], v[72:75], v[192:195], v[48:63]
    ds_read_b64_tr_b16 v[86:87], v122 offset:13568
    s_waitcnt lgkmcnt(3)
    v_mfma_f32_32x32x16_bf16 v[16:31], v[196:199], v[76:79], v[16:31]
    ds_read_b128 v[200:203], v10 offset:0
    ds_read_b128 v[64:67], v14 offset:4096
    s_waitcnt lgkmcnt(4)
    v_mfma_f32_32x32x16_bf16 v[32:47], v[196:199], v[80:83], v[32:47]
    ds_read_b128 v[68:71], v14 offset:18432
    ds_read_b64_tr_b16 v[72:73], v122 offset:20480
    s_waitcnt lgkmcnt(4)
    v_mfma_f32_32x32x16_bf16 v[48:63], v[84:87], v[196:199], v[48:63]
    ds_read_b64_tr_b16 v[74:75], v122 offset:20736
    s_waitcnt lgkmcnt(3)
    v_mfma_f32_32x32x16_bf16 v[16:31], v[200:203], v[64:67], v[16:31]
    ds_read_b128 v[204:207], v11 offset:0
    ds_read_b128 v[76:79], v15 offset:4096
    s_waitcnt lgkmcnt(4)
    v_mfma_f32_32x32x16_bf16 v[32:47], v[200:203], v[68:71], v[32:47]
    ds_read_b128 v[80:83], v15 offset:18432
    ds_read_b64_tr_b16 v[84:85], v122 offset:27648
    s_waitcnt lgkmcnt(4)
    v_mfma_f32_32x32x16_bf16 v[48:63], v[72:75], v[200:203], v[48:63]
    ds_read_b64_tr_b16 v[86:87], v122 offset:27904
    s_waitcnt lgkmcnt(3)
    v_mfma_f32_32x32x16_bf16 v[16:31], v[204:207], v[76:79], v[16:31]
    s_waitcnt lgkmcnt(0)
    s_barrier
    ds_read_b128 v[208:211], v8 offset:28672
    ds_read_b128 v[64:67], v12 offset:32768
    v_mfma_f32_32x32x16_bf16 v[32:47], v[204:207], v[80:83], v[32:47]
    ds_read_b128 v[68:71], v12 offset:47104
    ds_read_b64_tr_b16 v[72:73], v122 offset:34816
    ds_read_b64_tr_b16 v[74:75], v122 offset:35072
    v_mfma_f32_32x32x16_bf16 v[48:63], v[84:87], v[204:207], v[48:63]
    s_waitcnt lgkmcnt(3)
    v_mfma_f32_32x32x16_bf16 v[16:31], v[208:211], v[64:67], v[16:31]
    ds_read_b128 v[212:215], v9 offset:28672
    ds_read_b128 v[76:79], v13 offset:32768
    s_waitcnt lgkmcnt(4)
    v_mfma_f32_32x32x16_bf16 v[32:47], v[208:211], v[68:71], v[32:47]
    ds_read_b128 v[80:83], v13 offset:47104
    ds_read_b64_tr_b16 v[84:85], v122 offset:41984
    s_waitcnt lgkmcnt(4)
    v_mfma_f32_32x32x16_bf16 v[48:63], v[72:75], v[208:211], v[48:63]
    ds_read_b64_tr_b16 v[86:87], v122 offset:42240
    s_waitcnt lgkmcnt(3)
    v_mfma_f32_32x32x16_bf16 v[16:31], v[212:215], v[76:79], v[16:31]
    ds_read_b128 v[216:219], v10 offset:28672
    ds_read_b128 v[64:67], v14 offset:32768
    s_waitcnt lgkmcnt(4)
    v_mfma_f32_32x32x16_bf16 v[32:47], v[212:215], v[80:83], v[32:47]
    ds_read_b128 v[68:71], v14 offset:47104
    ds_read_b64_tr_b16 v[72:73], v122 offset:49152
    s_waitcnt lgkmcnt(4)
    v_mfma_f32_32x32x16_bf16 v[48:63], v[84:87], v[212:215], v[48:63]
    ds_read_b64_tr_b16 v[74:75], v122 offset:49408
    s_waitcnt lgkmcnt(3)
    v_mfma_f32_32x32x16_bf16 v[16:31], v[216:219], v[64:67], v[16:31]
    ds_read_b128 v[220:223], v11 offset:28672
    ds_read_b128 v[76:79], v15 offset:32768
    s_waitcnt lgkmcnt(4)
    v_mfma_f32_32x32x16_bf16 v[32:47], v[216:219], v[68:71], v[32:47]
    ds_read_b128 v[80:83], v15 offset:47104
    ds_read_b64_tr_b16 v[84:85], v122 offset:56320
    s_waitcnt lgkmcnt(4)
    v_mfma_f32_32x32x16_bf16 v[48:63], v[72:75], v[216:219], v[48:63]
    ds_read_b64_tr_b16 v[86:87], v122 offset:56576
    s_waitcnt lgkmcnt(3)
    v_mfma_f32_32x32x16_bf16 v[16:31], v[220:223], v[76:79], v[16:31]
    s_mov_b32 s13, 57344
    v_add_u32 v8, s13, v8
    v_add_u32 v9, s13, v9
    v_add_u32 v10, s13, v10
    v_add_u32 v11, s13, v11
    v_add_u32 v12, s13, v12
    v_add_u32 v13, s13, v13
    v_add_u32 v14, s13, v14
    v_add_u32 v15, s13, v15
    v_add_u32 v122, s13, v122
    s_waitcnt lgkmcnt(0)
    s_barrier
    ds_read_b128 v[224:227], v8 offset:0
    ds_read_b128 v[64:67], v12 offset:4096
    v_mfma_f32_32x32x16_bf16 v[32:47], v[220:223], v[80:83], v[32:47]
    ds_read_b128 v[68:71], v12 offset:18432
    ds_read_b64_tr_b16 v[72:73], v122 offset:6144
    ds_read_b64_tr_b16 v[74:75], v122 offset:6400
    v_mfma_f32_32x32x16_bf16 v[48:63], v[84:87], v[220:223], v[48:63]
    s_waitcnt lgkmcnt(3)
    v_mfma_f32_32x32x16_bf16 v[16:31], v[224:227], v[64:67], v[16:31]
    ds_read_b128 v[228:231], v9 offset:0
    ds_read_b128 v[76:79], v13 offset:4096
    s_waitcnt lgkmcnt(4)
    v_mfma_f32_32x32x16_bf16 v[32:47], v[224:227], v[68:71], v[32:47]
    ds_read_b128 v[80:83], v13 offset:18432
    ds_read_b64_tr_b16 v[84:85], v122 offset:13312
    s_waitcnt lgkmcnt(4)
    v_mfma_f32_32x32x16_bf16 v[48:63], v[72:75], v[224:227], v[48:63]
    ds_read_b64_tr_b16 v[86:87], v122 offset:13568
    s_waitcnt lgkmcnt(3)
    v_mfma_f32_32x32x16_bf16 v[16:31], v[228:231], v[76:79], v[16:31]
    ds_read_b128 v[232:235], v10 offset:0
    ds_read_b128 v[64:67], v14 offset:4096
    s_waitcnt lgkmcnt(4)
    v_mfma_f32_32x32x16_bf16 v[32:47], v[228:231], v[80:83], v[32:47]
    ds_read_b128 v[68:71], v14 offset:18432
    ds_read_b64_tr_b16 v[72:73], v122 offset:20480
    s_waitcnt lgkmcnt(4)
    v_mfma_f32_32x32x16_bf16 v[48:63], v[84:87], v[228:231], v[48:63]
    ds_read_b64_tr_b16 v[74:75], v122 offset:20736
    s_waitcnt lgkmcnt(3)
    v_mfma_f32_32x32x16_bf16 v[16:31], v[232:235], v[64:67], v[16:31]
    ds_read_b128 v[236:239], v11 offset:0
    ds_read_b128 v[76:79], v15 offset:4096
    s_waitcnt lgkmcnt(4)
    v_mfma_f32_32x32x16_bf16 v[32:47], v[232:235], v[68:71], v[32:47]
    ds_read_b128 v[80:83], v15 offset:18432
    ds_read_b64_tr_b16 v[84:85], v122 offset:27648
    s_waitcnt lgkmcnt(4)
    v_mfma_f32_32x32x16_bf16 v[48:63], v[72:75], v[232:235], v[48:63]
    ds_read_b64_tr_b16 v[86:87], v122 offset:27904
    s_waitcnt lgkmcnt(3)
    v_mfma_f32_32x32x16_bf16 v[16:31], v[236:239], v[76:79], v[16:31]
    s_waitcnt lgkmcnt(0)
    s_barrier
    ds_read_b128 v[240:243], v8 offset:28672
    ds_read_b128 v[64:67], v12 offset:32768
    v_mfma_f32_32x32x16_bf16 v[32:47], v[236:239], v[80:83], v[32:47]
    ds_read_b128 v[68:71], v12 offset:47104
    ds_read_b64_tr_b16 v[72:73], v122 offset:34816
    ds_read_b64_tr_b16 v[74:75], v122 offset:35072
    v_mfma_f32_32x32x16_bf16 v[48:63], v[84:87], v[236:239], v[48:63]
    s_waitcnt lgkmcnt(3)
    v_mfma_f32_32x32x16_bf16 v[16:31], v[240:243], v[64:67], v[16:31]
    ds_read_b128 v[244:247], v9 offset:28672
    ds_read_b128 v[76:79], v13 offset:32768
    s_waitcnt lgkmcnt(4)
    v_mfma_f32_32x32x16_bf16 v[32:47], v[240:243], v[68:71], v[32:47]
    ds_read_b128 v[80:83], v13 offset:47104
    ds_read_b64_tr_b16 v[84:85], v122 offset:41984
    s_waitcnt lgkmcnt(4)
    v_mfma_f32_32x32x16_bf16 v[48:63], v[72:75], v[240:243], v[48:63]
    ds_read_b64_tr_b16 v[86:87], v122 offset:42240
    s_waitcnt lgkmcnt(3)
    v_mfma_f32_32x32x16_bf16 v[16:31], v[244:247], v[76:79], v[16:31]
    ds_read_b128 v[248:251], v10 offset:28672
    ds_read_b128 v[64:67], v14 offset:32768
    s_waitcnt lgkmcnt(4)
    v_mfma_f32_32x32x16_bf16 v[32:47], v[244:247], v[80:83], v[32:47]
    ds_read_b128 v[68:71], v14 offset:47104
    ds_read_b64_tr_b16 v[72:73], v122 offset:49152
    s_waitcnt lgkmcnt(4)
    v_mfma_f32_32x32x16_bf16 v[48:63], v[84:87], v[244:247], v[48:63]
    ds_read_b64_tr_b16 v[74:75], v122 offset:49408
    s_waitcnt lgkmcnt(3)
    v_mfma_f32_32x32x16_bf16 v[16:31], v[248:251], v[64:67], v[16:31]
    ds_read_b128 v[252:255], v11 offset:28672
    ds_read_b128 v[76:79], v15 offset:32768
    s_waitcnt lgkmcnt(4)
    v_mfma_f32_32x32x16_bf16 v[32:47], v[248:251], v[68:71], v[32:47]
    ds_read_b128 v[80:83], v15 offset:47104
    ds_read_b64_tr_b16 v[84:85], v122 offset:56320
    s_waitcnt lgkmcnt(4)
    v_mfma_f32_32x32x16_bf16 v[48:63], v[72:75], v[248:251], v[48:63]
    ds_read_b64_tr_b16 v[86:87], v122 offset:56576
    s_waitcnt lgkmcnt(3)
    v_mfma_f32_32x32x16_bf16 v[16:31], v[252:255], v[76:79], v[16:31]
    v_lshlrev_b32 v116, 3, v1
    v_add_u32 v116, 153600, v116
    s_waitcnt lgkmcnt(2)
    v_mfma_f32_32x32x16_bf16 v[32:47], v[252:255], v[80:83], v[32:47]
    ds_read_b64 v[112:113], v116
    ds_read_b64 v[8:9], v116 offset:2560
    ds_read_b64 v[10:11], v116 offset:5120
    s_waitcnt lgkmcnt(3)
    v_mfma_f32_32x32x16_bf16 v[48:63], v[84:87], v[252:255], v[48:63]
    v_add_u32 v122, 57344, v122
    s_waitcnt lgkmcnt(0)
    v_mov_b32 v114, v113
    s_nop 4
.p2align 3
    v_pk_fma_f32 v[96:97], v[16:17], v[112:113], v[18:19] op_sel_hi:[1,0,1]
    v_pk_fma_f32 v[98:99], v[32:33], v[112:113], v[34:35] op_sel_hi:[1,0,1]
    v_pk_fma_f32 v[96:97], v[32:33], v[114:115], v[96:97] op_sel_hi:[1,0,1] neg_lo:[0,1,0] neg_hi:[0,1,0]
    v_pk_fma_f32 v[98:99], v[16:17], v[114:115], v[98:99] op_sel_hi:[1,0,1]
    v_pk_fma_f32 v[100:101], v[96:97], v[112:113], v[20:21] op_sel_hi:[1,0,1]
    v_pk_fma_f32 v[102:103], v[98:99], v[112:113], v[36:37] op_sel_hi:[1,0,1]
    v_pk_fma_f32 v[100:101], v[98:99], v[114:115], v[100:101] op_sel_hi:[1,0,1] neg_lo:[0,1,0] neg_hi:[0,1,0]
    v_pk_fma_f32 v[102:103], v[96:97], v[114:115], v[102:103] op_sel_hi:[1,0,1]
    v_pk_fma_f32 v[96:97], v[100:101], v[112:113], v[22:23] op_sel_hi:[1,0,1]
    v_pk_fma_f32 v[98:99], v[102:103], v[112:113], v[38:39] op_sel_hi:[1,0,1]
    v_pk_fma_f32 v[96:97], v[102:103], v[114:115], v[96:97] op_sel_hi:[1,0,1] neg_lo:[0,1,0] neg_hi:[0,1,0]
    v_pk_fma_f32 v[98:99], v[100:101], v[114:115], v[98:99] op_sel_hi:[1,0,1]
    v_pk_fma_f32 v[100:101], v[96:97], v[112:113], v[24:25] op_sel_hi:[1,0,1]
    v_pk_fma_f32 v[102:103], v[98:99], v[112:113], v[40:41] op_sel_hi:[1,0,1]
    v_pk_fma_f32 v[100:101], v[98:99], v[114:115], v[100:101] op_sel_hi:[1,0,1] neg_lo:[0,1,0] neg_hi:[0,1,0]
    v_pk_fma_f32 v[102:103], v[96:97], v[114:115], v[102:103] op_sel_hi:[1,0,1]
    v_pk_fma_f32 v[96:97], v[100:101], v[112:113], v[26:27] op_sel_hi:[1,0,1]
    v_pk_fma_f32 v[98:99], v[102:103], v[112:113], v[42:43] op_sel_hi:[1,0,1]
    v_pk_fma_f32 v[96:97], v[102:103], v[114:115], v[96:97] op_sel_hi:[1,0,1] neg_lo:[0,1,0] neg_hi:[0,1,0]
    v_pk_fma_f32 v[98:99], v[100:101], v[114:115], v[98:99] op_sel_hi:[1,0,1]
    v_pk_fma_f32 v[100:101], v[96:97], v[112:113], v[28:29] op_sel_hi:[1,0,1]
    v_pk_fma_f32 v[102:103], v[98:99], v[112:113], v[44:45] op_sel_hi:[1,0,1]
    v_pk_fma_f32 v[100:101], v[98:99], v[114:115], v[100:101] op_sel_hi:[1,0,1] neg_lo:[0,1,0] neg_hi:[0,1,0]
    v_pk_fma_f32 v[102:103], v[96:97], v[114:115], v[102:103] op_sel_hi:[1,0,1]
    v_pk_fma_f32 v[96:97], v[100:101], v[112:113], v[30:31] op_sel_hi:[1,0,1]
    v_pk_fma_f32 v[98:99], v[102:103], v[112:113], v[46:47] op_sel_hi:[1,0,1]
    v_pk_fma_f32 v[96:97], v[102:103], v[114:115], v[96:97] op_sel_hi:[1,0,1] neg_lo:[0,1,0] neg_hi:[0,1,0]
    v_pk_fma_f32 v[98:99], v[100:101], v[114:115], v[98:99] op_sel_hi:[1,0,1]
    v_swap_b32 v97, v98
    ds_write_b128 v123, v[96:99]
    ds_read_b128 v[104:107], v124
    ds_read_b128 v[80:83], v6 offset:384
    ds_read_b128 v[84:87], v6 offset:416
    ds_read_b128 v[88:91], v6 offset:448
    ds_read_b128 v[92:95], v6 offset:480
    s_mov_b32 s15, 200000
    s_waitcnt lgkmcnt(4)
    s_barrier
    ds_read_b128 v[64:67], v6 offset:0
    ds_read_b128 v[68:71], v6 offset:32
    ds_read_b128 v[72:75], v6 offset:64
    ds_read_b128 v[76:79], v6 offset:96
L_C_ST:
    v_cmp_ne_u32 vcc, s11, v107
    s_sub_u32 s15, s15, 1
    s_cmp_eq_u32 s15, 0
    s_cbranch_vccz L_C_STOK
    s_cbranch_scc1 L_C_STOK
    buffer_load_dwordx4 v[104:107], v125, s[76:79], s90 offen sc1
    s_waitcnt vmcnt(0)
    s_branch L_C_ST
L_C_STOK:
    v_sub_f32 v120, 1.0, v106
    v_sub_f32 v116, 0, v104
    v_mov_b32 v118, v105
    v_cvt_pk_bf16_f32 v120, v120, v120
    v_and_b32 v120, 0xffff0000, v120
    v_add_f32 v121, v106, v106
    v_max_f32 v120, 0x0da24260, v120
    s_lshl_b32 s13, s3, 7
    v_rcp_f32 v120, v120
    s_add_u32 s13, s13, 152320
    v_lshl_add_u32 v124, v1, 2, s13
    ds_write_b32 v124, v121
    v_mov_b32 v125, 163344
    s_lshl_b32 s13, s3, 2
    s_add_u32 s13, s13, 163360
    v_mov_b32 v124, s13
    v_mov_b32 v123, 1
    v_mov_b32 v15, 163340
    s_lshr_b32 s13, s3, 1
    s_cmp_lg_u32 s13, s7
    s_cbranch_scc1 L_C_XD8
    s_and_b32 s13, s2, 6
    s_lshl_b32 s14, s2, 2
    s_add_u32 s13, s13, s14
    s_sub_u32 s13, s8, s13
    s_and_b32 s13, s13, 7
    s_and_b32 s14, s3, 1
    s_mul_i32 s14, s14, 4608
    s_add_u32 s14, s14, 99328
    v_mul_u32_u24 v115, 144, v1
    v_lshl_add_u32 v115, v2, 4, v115
    v_add_u32 v115, s14, v115
    s_cmp_lg_u32 s13, 0
    s_cbranch_scc1 L_C_XD0
    ds_write_b128 v115, v[128:131] offset:0
    ds_write_b128 v115, v[132:135] offset:32
    ds_write_b128 v115, v[136:139] offset:64
    ds_write_b128 v115, v[140:143] offset:96
    s_branch L_C_XD8
L_C_XD0:
    s_cmp_lg_u32 s13, 1
    s_cbranch_scc1 L_C_XD1
    ds_write_b128 v115, v[144:147] offset:0
    ds_write_b128 v115, v[148:151] offset:32
    ds_write_b128 v115, v[152:155] offset:64
    ds_write_b128 v115, v[156:159] offset:96
    s_branch L_C_XD8
L_C_XD1:
    s_cmp_lg_u32 s13, 2
    s_cbranch_scc1 L_C_XD2
    ds_write_b128 v115, v[160:163] offset:0
    ds_write_b128 v115, v[164:167] offset:32
    ds_write_b128 v115, v[168:171] offset:64
    ds_write_b128 v115, v[172:175] offset:96
    s_branch L_C_XD8
L_C_XD2:
    s_cmp_lg_u32 s13, 3
    s_cbranch_scc1 L_C_XD3
    ds_write_b128 v115, v[176:179] offset:0
    ds_write_b128 v115, v[180:183] offset:32
    ds_write_b128 v115, v[184:187] offset:64
    ds_write_b128 v115, v[188:191] offset:96
    s_branch L_C_XD8
L_C_XD3:
    s_cmp_lg_u32 s13, 4
    s_cbranch_scc1 L_C_XD4
    ds_write_b128 v115, v[192:195] offset:0
    ds_write_b128 v115, v[196:199] offset:32
    ds_write_b128 v115, v[200:203] offset:64
    ds_write_b128 v115, v[204:207] offset:96
    s_branch L_C_XD8
L_C_XD4:
    s_cmp_lg_u32 s13, 5
    s_cbranch_scc1 L_C_XD5
    ds_write_b128 v115, v[208:211] offset:0
    ds_write_b128 v115, v[212:215] offset:32
    ds_write_b128 v115, v[216:219] offset:64
    ds_write_b128 v115, v[220:223] offset:96
    s_branch L_C_XD8
L_C_XD5:
    s_cmp_lg_u32 s13, 6
    s_cbranch_scc1 L_C_XD6
    ds_write_b128 v115, v[224:227] offset:0
    ds_write_b128 v115, v[228:231] offset:32
    ds_write_b128 v115, v[232:235] offset:64
    ds_write_b128 v115, v[236:239] offset:96
    s_branch L_C_XD8
L_C_XD6:
    ds_write_b128 v115, v[240:243] offset:0
    ds_write_b128 v115, v[244:247] offset:32
    ds_write_b128 v115, v[248:251] offset:64
    ds_write_b128 v115, v[252:255] offset:96
L_C_XD8:
L_C_LOOP:
    s_waitcnt lgkmcnt(0)
    v_cmp_eq_u32 vcc, 0, v123
    s_mov_b32 s15, 1600000
    s_nop 0
    s_cbranch_vccz L_C_GD
L_C_GR:
    ds_read_b32 v123, v15 offset:64
    ds_read_b128 v[64:67], v6 offset:0
    ds_read_b128 v[68:71], v6 offset:32
    ds_read_b128 v[72:75], v6 offset:64
    ds_read_b128 v[76:79], v6 offset:96
    s_sub_u32 s15, s15, 1
    s_waitcnt lgkmcnt(0)
    v_cmp_eq_u32 vcc, 0, v123
    s_cmp_eq_u32 s15, 0
    s_cbranch_scc1 L_C_GD
    s_cbranch_vccnz L_C_GR
L_C_GD:
.p2align 3
    v_pk_fma_f32 v[48:49], v[64:65], v[116:117], v[48:49] op_sel_hi:[1,0,1]
    v_pk_fma_f32 v[50:51], v[66:67], v[116:117], v[50:51] op_sel_hi:[1,0,1]
    v_pk_fma_f32 v[52:53], v[68:69], v[116:117], v[52:53] op_sel_hi:[1,0,1]
    v_pk_fma_f32 v[54:55], v[70:71], v[116:117], v[54:55] op_sel_hi:[1,0,1]
    v_pk_fma_f32 v[56:57], v[72:73], v[116:117], v[56:57] op_sel_hi:[1,0,1]
    v_pk_fma_f32 v[58:59], v[74:75], v[116:117], v[58:59] op_sel_hi:[1,0,1]
    v_pk_fma_f32 v[60:61], v[76:77], v[116:117], v[60:61] op_sel_hi:[1,0,1]
    v_pk_fma_f32 v[62:63], v[78:79], v[116:117], v[62:63] op_sel_hi:[1,0,1]
    v_pk_fma_f32 v[48:49], v[48:49], v[118:119], v[80:81] op_sel_hi:[1,0,1]
    v_pk_fma_f32 v[50:51], v[50:51], v[118:119], v[82:83] op_sel_hi:[1,0,1]
    v_pk_fma_f32 v[52:53], v[52:53], v[118:119], v[84:85] op_sel_hi:[1,0,1]
    v_pk_fma_f32 v[54:55], v[54:55], v[118:119], v[86:87] op_sel_hi:[1,0,1]
    v_pk_fma_f32 v[56:57], v[56:57], v[118:119], v[88:89] op_sel_hi:[1,0,1]
    v_pk_fma_f32 v[58:59], v[58:59], v[118:119], v[90:91] op_sel_hi:[1,0,1]
    v_pk_fma_f32 v[60:61], v[60:61], v[118:119], v[92:93] op_sel_hi:[1,0,1]
    v_pk_fma_f32 v[62:63], v[62:63], v[118:119], v[94:95] op_sel_hi:[1,0,1]
    v_pk_mul_f32 v[64:65], v[48:49], v[48:49]
    v_pk_mul_f32 v[66:67], v[50:51], v[50:51]
    v_pk_mul_f32 v[68:69], v[52:53], v[52:53]
    v_pk_mul_f32 v[70:71], v[54:55], v[54:55]
    v_pk_mul_f32 v[72:73], v[56:57], v[56:57]
    v_pk_mul_f32 v[74:75], v[58:59], v[58:59]
    v_pk_mul_f32 v[76:77], v[60:61], v[60:61]
    v_pk_mul_f32 v[78:79], v[62:63], v[62:63]
    v_pk_fma_f32 v[64:65], v[64:65], s[86:87], s[86:87] op_sel:[0,0,1] op_sel_hi:[1,0,1]
    v_pk_fma_f32 v[66:67], v[66:67], s[86:87], s[86:87] op_sel:[0,0,1] op_sel_hi:[1,0,1]
    v_pk_fma_f32 v[68:69], v[68:69], s[86:87], s[86:87] op_sel:[0,0,1] op_sel_hi:[1,0,1]
    v_pk_fma_f32 v[70:71], v[70:71], s[86:87], s[86:87] op_sel:[0,0,1] op_sel_hi:[1,0,1]
    v_pk_fma_f32 v[72:73], v[72:73], s[86:87], s[86:87] op_sel:[0,0,1] op_sel_hi:[1,0,1]
    v_pk_fma_f32 v[74:75], v[74:75], s[86:87], s[86:87] op_sel:[0,0,1] op_sel_hi:[1,0,1]
    v_pk_fma_f32 v[76:77], v[76:77], s[86:87], s[86:87] op_sel:[0,0,1] op_sel_hi:[1,0,1]
    v_pk_fma_f32 v[78:79], v[78:79], s[86:87], s[86:87] op_sel:[0,0,1] op_sel_hi:[1,0,1]
    v_pk_mul_f32 v[64:65], v[64:65], v[48:49]
    v_pk_mul_f32 v[66:67], v[66:67], v[50:51]
    v_pk_mul_f32 v[68:69], v[68:69], v[52:53]
    v_pk_mul_f32 v[70:71], v[70:71], v[54:55]
    v_pk_mul_f32 v[72:73], v[72:73], v[56:57]
    v_pk_mul_f32 v[74:75], v[74:75], v[58:59]
    v_pk_mul_f32 v[76:77], v[76:77], v[60:61]
    v_pk_mul_f32 v[78:79], v[78:79], v[62:63]
    v_exp_f32 v64, v64
    v_exp_f32 v65, v65
    v_exp_f32 v66, v66
    v_exp_f32 v67, v67
    v_exp_f32 v68, v68
    v_exp_f32 v69, v69
    v_exp_f32 v70, v70
    v_exp_f32 v71, v71
    v_exp_f32 v72, v72
    v_exp_f32 v73, v73
    v_exp_f32 v74, v74
    v_exp_f32 v75, v75
    v_exp_f32 v76, v76
    v_exp_f32 v77, v77
    v_exp_f32 v78, v78
    v_exp_f32 v79, v79
.p2align 3
    v_pk_fma_f32 v[64:65], v[64:65], v[120:121], v[120:121] op_sel_hi:[1,0,0]
    v_pk_fma_f32 v[66:67], v[66:67], v[120:121], v[120:121] op_sel_hi:[1,0,0]
    v_pk_fma_f32 v[68:69], v[68:69], v[120:121], v[120:121] op_sel_hi:[1,0,0]
    v_pk_fma_f32 v[70:71], v[70:71], v[120:121], v[120:121] op_sel_hi:[1,0,0]
    v_pk_fma_f32 v[72:73], v[72:73], v[120:121], v[120:121] op_sel_hi:[1,0,0]
    v_pk_fma_f32 v[74:75], v[74:75], v[120:121], v[120:121] op_sel_hi:[1,0,0]
    v_pk_fma_f32 v[76:77], v[76:77], v[120:121], v[120:121] op_sel_hi:[1,0,0]
    v_pk_fma_f32 v[78:79], v[78:79], v[120:121], v[120:121] op_sel_hi:[1,0,0]
    v_rcp_f32 v64, v64
    v_rcp_f32 v65, v65
    v_rcp_f32 v66, v66
    v_rcp_f32 v67, v67
    v_rcp_f32 v68, v68
    v_rcp_f32 v69, v69
    v_rcp_f32 v70, v70
    v_rcp_f32 v71, v71
    s_add_u32 s14, s85, 4096
    s_add_u32 s84, s84, 1
    v_pk_mul_f32 v[64:65], v[64:65], v[48:49]
    v_pk_mul_f32 v[66:67], v[66:67], v[50:51]
    v_pk_mul_f32 v[68:69], v[68:69], v[52:53]
    v_pk_mul_f32 v[70:71], v[70:71], v[54:55]
    v_cvt_pk_bf16_f32 v80, v64, v65
    v_cvt_pk_bf16_f32 v81, v66, v67
    v_cvt_pk_bf16_f32 v82, v68, v69
    v_cvt_pk_bf16_f32 v83, v70, v71
    buffer_store_dwordx4 v[80:83], v4, s[76:79], s85 offen sc1
    v_rcp_f32 v72, v72
    v_rcp_f32 v73, v73
    v_rcp_f32 v74, v74
    v_rcp_f32 v75, v75
    v_rcp_f32 v76, v76
    v_rcp_f32 v77, v77
    v_rcp_f32 v78, v78
    v_rcp_f32 v79, v79
    s_nop 0
    v_pk_mul_f32 v[72:73], v[72:73], v[56:57]
    v_pk_mul_f32 v[74:75], v[74:75], v[58:59]
    v_pk_mul_f32 v[76:77], v[76:77], v[60:61]
    v_pk_mul_f32 v[78:79], v[78:79], v[62:63]
    v_cvt_pk_bf16_f32 v84, v72, v73
    v_cvt_pk_bf16_f32 v85, v74, v75
    v_cvt_pk_bf16_f32 v86, v76, v77
    v_cvt_pk_bf16_f32 v87, v78, v79
    buffer_store_dwordx4 v[84:87], v4, s[76:79], s14 offen sc1
    s_cmp_eq_u32 s84, s10
    s_cbranch_scc1 L_C_TAIL
    s_mov_b32 s15, 1600000
L_C_FW:
    ds_read_b128 v[64:67], v125
    s_sub_u32 s15, s15, 1
    s_waitcnt lgkmcnt(0)
    v_and_b32 v64, v64, v65
    v_and_b32 v66, v66, v67
    v_and_b32 v64, v64, v66
    v_cmp_eq_u32 vcc, 0, v64
    s_cmp_eq_u32 s15, 0
    s_cbranch_scc1 L_C_FD
    s_cbranch_vccnz L_C_FW
L_C_FD:
    ds_read_b64_tr_b16 v[96:97], v122 offset:0
    ds_read_b64_tr_b16 v[98:99], v122 offset:256
    ds_read_b64_tr_b16 v[100:101], v122 offset:1024
    ds_read_b64_tr_b16 v[102:103], v122 offset:1280
    ds_read_b64_tr_b16 v[104:105], v122 offset:2048
    ds_read_b64_tr_b16 v[106:107], v122 offset:2304
    ds_read_b64_tr_b16 v[108:109], v122 offset:3072
    ds_read_b64_tr_b16 v[110:111], v122 offset:3328
    ds_read_b64_tr_b16 v[64:65], v122 offset:4096
    ds_read_b64_tr_b16 v[66:67], v122 offset:4352
    ds_read_b64_tr_b16 v[68:69], v122 offset:5120
    ds_read_b64_tr_b16 v[70:71], v122 offset:5376
    s_add_u32 s85, s85, 8192
    v_add_u32 v6, 128, v6
    v_add_u32 v15, 4, v15
    s_waitcnt lgkmcnt(10)
    v_mfma_f32_32x32x16_bf16 v[48:63], v[96:99], v[128:131], 0
    ds_read_b64_tr_b16 v[72:73], v122 offset:6144
    ds_read_b64_tr_b16 v[74:75], v122 offset:6400
    s_waitcnt lgkmcnt(10)
    v_mfma_f32_32x32x16_bf16 v[48:63], v[100:103], v[132:135], v[48:63]
    ds_read_b64_tr_b16 v[76:77], v122 offset:7168
    ds_read_b64_tr_b16 v[78:79], v122 offset:7424
    s_waitcnt lgkmcnt(10)
    v_mfma_f32_32x32x16_bf16 v[48:63], v[104:107], v[136:139], v[48:63]
    ds_read_b64_tr_b16 v[96:97], v122 offset:8192
    ds_read_b64_tr_b16 v[98:99], v122 offset:8448
    s_waitcnt lgkmcnt(10)
    v_mfma_f32_32x32x16_bf16 v[48:63], v[108:111], v[140:143], v[48:63]
    ds_read_b64_tr_b16 v[100:101], v122 offset:9216
    ds_read_b64_tr_b16 v[102:103], v122 offset:9472
    s_waitcnt lgkmcnt(10)
    v_mfma_f32_32x32x16_bf16 v[48:63], v[64:67], v[144:147], v[48:63]
    ds_read_b64_tr_b16 v[104:105], v122 offset:10240
    ds_read_b64_tr_b16 v[106:107], v122 offset:10496
    s_waitcnt lgkmcnt(10)
    v_mfma_f32_32x32x16_bf16 v[48:63], v[68:71], v[148:151], v[48:63]
    ds_read_b64_tr_b16 v[108:109], v122 offset:11264
    ds_read_b64_tr_b16 v[110:111], v122 offset:11520
    s_waitcnt lgkmcnt(10)
    v_mfma_f32_32x32x16_bf16 v[48:63], v[72:75], v[152:155], v[48:63]
    ds_read_b64_tr_b16 v[64:65], v122 offset:12288
    ds_read_b64_tr_b16 v[66:67], v122 offset:12544
    s_waitcnt lgkmcnt(10)
    v_mfma_f32_32x32x16_bf16 v[48:63], v[76:79], v[156:159], v[48:63]
    ds_read_b64_tr_b16 v[68:69], v122 offset:13312
    ds_read_b64_tr_b16 v[70:71], v122 offset:13568
    s_waitcnt lgkmcnt(10)
    v_mfma_f32_32x32x16_bf16 v[48:63], v[96:99], v[160:163], v[48:63]
    ds_read_b64_tr_b16 v[72:73], v122 offset:14336
    ds_read_b64_tr_b16 v[74:75], v122 offset:14592
    s_waitcnt lgkmcnt(10)
    v_mfma_f32_32x32x16_bf16 v[48:63], v[100:103], v[164:167], v[48:63]
    ds_read_b64_tr_b16 v[76:77], v122 offset:15360
    ds_read_b64_tr_b16 v[78:79], v122 offset:15616
    s_waitcnt lgkmcnt(10)
    v_mfma_f32_32x32x16_bf16 v[48:63], v[104:107], v[168:171], v[48:63]
    ds_read_b64_tr_b16 v[96:97], v122 offset:16384
    ds_read_b64_tr_b16 v[98:99], v122 offset:16640
    s_waitcnt lgkmcnt(10)
    v_mfma_f32_32x32x16_bf16 v[48:63], v[108:111], v[172:175], v[48:63]
    ds_read_b64_tr_b16 v[100:101], v122 offset:17408
    ds_read_b64_tr_b16 v[102:103], v122 offset:17664
    s_waitcnt lgkmcnt(10)
    v_mfma_f32_32x32x16_bf16 v[48:63], v[64:67], v[176:179], v[48:63]
    ds_read_b64_tr_b16 v[104:105], v122 offset:18432
    ds_read_b64_tr_b16 v[106:107], v122 offset:18688
    s_waitcnt lgkmcnt(10)
    v_mfma_f32_32x32x16_bf16 v[48:63], v[68:71], v[180:183], v[48:63]
    ds_read_b64_tr_b16 v[108:109], v122 offset:19456
    ds_read_b64_tr_b16 v[110:111], v122 offset:19712
    s_waitcnt lgkmcnt(10)
    v_mfma_f32_32x32x16_bf16 v[48:63], v[72:75], v[184:187], v[48:63]
    ds_read_b64_tr_b16 v[64:65], v122 offset:20480
    ds_read_b64_tr_b16 v[66:67], v122 offset:20736
    s_waitcnt lgkmcnt(10)
    v_mfma_f32_32x32x16_bf16 v[48:63], v[76:79], v[188:191], v[48:63]
    ds_read_b64_tr_b16 v[68:69], v122 offset:21504
    ds_read_b64_tr_b16 v[70:71], v122 offset:21760
    s_waitcnt lgkmcnt(10)
    v_mfma_f32_32x32x16_bf16 v[48:63], v[96:99], v[192:195], v[48:63]
    ds_read_b64_tr_b16 v[72:73], v122 offset:22528
    ds_read_b64_tr_b16 v[74:75], v122 offset:22784
    s_waitcnt lgkmcnt(10)
    v_mfma_f32_32x32x16_bf16 v[48:63], v[100:103], v[196:199], v[48:63]
    ds_read_b64_tr_b16 v[76:77], v122 offset:23552
    ds_read_b64_tr_b16 v[78:79], v122 offset:23808
    s_waitcnt lgkmcnt(10)
    v_mfma_f32_32x32x16_bf16 v[48:63], v[104:107], v[200:203], v[48:63]
    ds_read_b64_tr_b16 v[96:97], v122 offset:24576
    ds_read_b64_tr_b16 v[98:99], v122 offset:24832
    s_waitcnt lgkmcnt(10)
    v_mfma_f32_32x32x16_bf16 v[48:63], v[108:111], v[204:207], v[48:63]
    ds_read_b64_tr_b16 v[100:101], v122 offset:25600
    ds_read_b64_tr_b16 v[102:103], v122 offset:25856
    s_waitcnt lgkmcnt(10)
    v_mfma_f32_32x32x16_bf16 v[48:63], v[64:67], v[208:211], v[48:63]
    ds_read_b64_tr_b16 v[104:105], v122 offset:26624
    ds_read_b64_tr_b16 v[106:107], v122 offset:26880
    s_waitcnt vmcnt(0)
    buffer_store_dword v7, v5, s[76:79], s89 offen sc1
    s_add_u32 s89, s89, 128
    s_waitcnt lgkmcnt(10)
    v_mfma_f32_32x32x16_bf16 v[48:63], v[68:71], v[212:215], v[48:63]
    ds_read_b64_tr_b16 v[108:109], v122 offset:27648
    ds_read_b64_tr_b16 v[110:111], v122 offset:27904
    s_waitcnt lgkmcnt(10)
    v_mfma_f32_32x32x16_bf16 v[48:63], v[72:75], v[216:219], v[48:63]
    s_waitcnt lgkmcnt(8)
    v_mfma_f32_32x32x16_bf16 v[48:63], v[76:79], v[220:223], v[48:63]
    s_waitcnt lgkmcnt(6)
    v_mfma_f32_32x32x16_bf16 v[48:63], v[96:99], v[224:227], v[48:63]
    ds_read_b64_tr_b16 v[96:97], v122 offset:28672
    ds_read_b64_tr_b16 v[98:99], v122 offset:28928
    s_waitcnt lgkmcnt(6)
    v_mfma_f32_32x32x16_bf16 v[48:63], v[100:103], v[228:231], v[48:63]
    ds_read_b64_tr_b16 v[100:101], v122 offset:29696
    ds_read_b64_tr_b16 v[102:103], v122 offset:29952
    s_waitcnt lgkmcnt(6)
    v_mfma_f32_32x32x16_bf16 v[48:63], v[104:107], v[232:235], v[48:63]
    ds_read_b64_tr_b16 v[104:105], v122 offset:30720
    ds_read_b64_tr_b16 v[106:107], v122 offset:30976
    s_waitcnt lgkmcnt(6)
    v_mfma_f32_32x32x16_bf16 v[48:63], v[108:111], v[236:239], v[48:63]
    ds_read_b64_tr_b16 v[108:109], v122 offset:31744
    ds_read_b64_tr_b16 v[110:111], v122 offset:32000
    s_waitcnt lgkmcnt(6)
    v_mfma_f32_32x32x16_bf16 v[48:63], v[96:99], v[240:243], v[48:63]
    ds_read_b32 v123, v15 offset:64
    ds_read_b128 v[64:67], v6 offset:0
    ds_read_b128 v[68:71], v6 offset:32
    ds_read_b128 v[72:75], v6 offset:64
    ds_read_b128 v[76:79], v6 offset:96
    s_waitcnt lgkmcnt(9)
    v_mfma_f32_32x32x16_bf16 v[48:63], v[100:103], v[244:247], v[48:63]
    ds_read_b128 v[80:83], v6 offset:384
    ds_read_b128 v[84:87], v6 offset:416
    ds_read_b128 v[88:91], v6 offset:448
    ds_read_b128 v[92:95], v6 offset:480
    s_waitcnt lgkmcnt(11)
    v_mfma_f32_32x32x16_bf16 v[48:63], v[104:107], v[248:251], v[48:63]
    s_waitcnt lgkmcnt(9)
    v_mfma_f32_32x32x16_bf16 v[48:63], v[108:111], v[252:255], v[48:63]
    v_subrev_u32 v122, 114688, v122
    v_add_u32 v124, 16, v124
    ds_write_b32 v124, v126
    s_nop 3
    s_branch L_C_LOOP
L_C_TAIL:
    s_cmp_eq_u32 s10, 3
    s_cbranch_scc1 L_C_T3
    v_add_u32 v124, 16, v124
    ds_write_b32 v124, v126
    s_waitcnt vmcnt(0)
    buffer_store_dword v7, v5, s[76:79], s89 offen sc1
    s_add_u32 s89, s89, 128
L_C_T3:
    s_setprio 3
    v_lshlrev_b32 v128, 3, v1
    s_lshl_b32 s13, s3, 7
    s_add_u32 s13, s13, 152320
    v_lshl_add_u32 v129, v2, 4, s13
    ds_read_b128 v[152:155], v129 offset:0
    ds_read_b128 v[156:159], v129 offset:32
    ds_read_b128 v[160:163], v129 offset:64
    ds_read_b128 v[164:167], v129 offset:96
    v_add_u32 v130, 152832, v128
    v_mov_b32 v128, 163328
    ds_read_b32 v129, v128
    s_mov_b32 s84, 0
    s_waitcnt lgkmcnt(0)
    v_cmp_eq_u32 vcc, 0, v129
    s_mov_b32 s15, 1600000
    s_nop 0
    s_cbranch_vccz L_C_HOK
    s_waitcnt vmcnt(0)
    buffer_store_dword v7, v5, s[76:79], s89 offen sc1
    s_mov_b32 s84, 1
L_C_HW:
    ds_read_b32 v129, v128
    s_sub_u32 s15, s15, 1
    s_waitcnt lgkmcnt(0)
    v_cmp_eq_u32 vcc, 0, v129
    s_cmp_eq_u32 s15, 0
    s_cbranch_scc1 L_C_HOK
    s_cbranch_vccnz L_C_HW
L_C_HOK:
    ds_read_b64 v[132:133], v130
    v_lshlrev_b32 v128, 4, v1
    v_add_u32 v128, 147456, v128
    s_mov_b32 s15, s3
    v_mov_b32 v14, v9
    v_sub_f32 v12, 0, v11
    v_mov_b32 v13, v11
L_C_HL:
    ds_read_b128 v[136:139], v128
    ds_read_b128 v[140:143], v128 offset:512
    v_add_u32 v128, 1024, v128
    s_cmp_eq_u32 s15, 0
    s_waitcnt lgkmcnt(0)
    s_cbranch_scc1 L_C_HD
    v_pk_fma_f32 v[134:135], v[132:133], v[10:11], v[136:137] op_sel_hi:[1,0,1]
    v_pk_fma_f32 v[134:135], v[132:133], v[12:13], v[134:135] op_sel:[1,0,0] op_sel_hi:[0,1,1]
    v_pk_fma_f32 v[132:133], v[134:135], v[10:11], v[138:139] op_sel_hi:[1,0,1]
    v_pk_fma_f32 v[132:133], v[134:135], v[12:13], v[132:133] op_sel:[1,0,0] op_sel_hi:[0,1,1]
    v_pk_fma_f32 v[134:135], v[132:133], v[10:11], v[140:141] op_sel_hi:[1,0,1]
    v_pk_fma_f32 v[134:135], v[132:133], v[12:13], v[134:135] op_sel:[1,0,0] op_sel_hi:[0,1,1]
    v_pk_fma_f32 v[132:133], v[134:135], v[10:11], v[142:143] op_sel_hi:[1,0,1]
    v_pk_fma_f32 v[132:133], v[134:135], v[12:13], v[132:133] op_sel:[1,0,0] op_sel_hi:[0,1,1]
    s_sub_u32 s15, s15, 1
    s_branch L_C_HL
L_C_HD:
    v_cmp_eq_u32 vcc, 1, v2
    v_pk_fma_f32 v[134:135], v[132:133], v[10:11], v[136:137] op_sel_hi:[1,0,1]
    v_pk_fma_f32 v[134:135], v[132:133], v[12:13], v[134:135] op_sel:[1,0,0] op_sel_hi:[0,1,1]
    v_pk_fma_f32 v[144:145], v[134:135], v[10:11], v[138:139] op_sel_hi:[1,0,1]
    v_pk_fma_f32 v[144:145], v[134:135], v[12:13], v[144:145] op_sel:[1,0,0] op_sel_hi:[0,1,1]
    v_pk_fma_f32 v[146:147], v[144:145], v[10:11], v[140:141] op_sel_hi:[1,0,1]
    v_pk_fma_f32 v[146:147], v[144:145], v[12:13], v[146:147] op_sel:[1,0,0] op_sel_hi:[0,1,1]
    v_cndmask_b32 v148, v132, v144, vcc
    v_cndmask_b32 v149, v134, v146, vcc
    v_cndmask_b32 v150, v133, v145, vcc
    v_cndmask_b32 v151, v135, v147, vcc
.p2align 3
    v_pk_fma_f32 v[16:17], v[148:149], v[112:113], v[16:17] op_sel_hi:[1,0,1]
    v_pk_fma_f32 v[32:33], v[150:151], v[112:113], v[32:33] op_sel_hi:[1,0,1]
    v_pk_fma_f32 v[16:17], v[150:151], v[114:115], v[16:17] op_sel_hi:[1,0,1] neg_lo:[0,1,0] neg_hi:[0,1,0]
    v_pk_fma_f32 v[32:33], v[148:149], v[114:115], v[32:33] op_sel_hi:[1,0,1]
    v_pk_fma_f32 v[18:19], v[16:17], v[112:113], v[18:19] op_sel_hi:[1,0,1]
    v_pk_fma_f32 v[34:35], v[32:33], v[112:113], v[34:35] op_sel_hi:[1,0,1]
    v_pk_fma_f32 v[18:19], v[32:33], v[114:115], v[18:19] op_sel_hi:[1,0,1] neg_lo:[0,1,0] neg_hi:[0,1,0]
    v_pk_fma_f32 v[34:35], v[16:17], v[114:115], v[34:35] op_sel_hi:[1,0,1]
    v_pk_mul_f32 v[184:185], v[16:17], v[8:9] op_sel_hi:[1,0]
    v_pk_mul_f32 v[186:187], v[32:33], v[8:9] op_sel_hi:[1,0] neg_lo:[0,1] neg_hi:[0,1]
    v_pk_fma_f32 v[184:185], v[32:33], v[14:15], v[184:185] op_sel_hi:[1,0,1] neg_lo:[0,1,0] neg_hi:[0,1,0]
    v_pk_fma_f32 v[186:187], v[16:17], v[14:15], v[186:187] op_sel_hi:[1,0,1] neg_lo:[0,1,0] neg_hi:[0,1,0]
    v_pk_mul_f32 v[184:185], v[184:185], v[152:153]
    v_pk_mul_f32 v[186:187], v[186:187], v[152:153]
    v_cvt_pk_bf16_f32 v168, v184, v185
    v_cvt_pk_bf16_f32 v176, v186, v187
    v_pk_fma_f32 v[20:21], v[18:19], v[112:113], v[20:21] op_sel_hi:[1,0,1]
    v_pk_fma_f32 v[36:37], v[34:35], v[112:113], v[36:37] op_sel_hi:[1,0,1]
    v_pk_fma_f32 v[20:21], v[34:35], v[114:115], v[20:21] op_sel_hi:[1,0,1] neg_lo:[0,1,0] neg_hi:[0,1,0]
    v_pk_fma_f32 v[36:37], v[18:19], v[114:115], v[36:37] op_sel_hi:[1,0,1]
    v_pk_mul_f32 v[184:185], v[18:19], v[8:9] op_sel_hi:[1,0]
    v_pk_mul_f32 v[186:187], v[34:35], v[8:9] op_sel_hi:[1,0] neg_lo:[0,1] neg_hi:[0,1]
    v_pk_fma_f32 v[184:185], v[34:35], v[14:15], v[184:185] op_sel_hi:[1,0,1] neg_lo:[0,1,0] neg_hi:[0,1,0]
    v_pk_fma_f32 v[186:187], v[18:19], v[14:15], v[186:187] op_sel_hi:[1,0,1] neg_lo:[0,1,0] neg_hi:[0,1,0]
    v_pk_mul_f32 v[184:185], v[184:185], v[154:155]
    v_pk_mul_f32 v[186:187], v[186:187], v[154:155]
    v_cvt_pk_bf16_f32 v169, v184, v185
    v_cvt_pk_bf16_f32 v177, v186, v187
    v_pk_fma_f32 v[22:23], v[20:21], v[112:113], v[22:23] op_sel_hi:[1,0,1]
    v_pk_fma_f32 v[38:39], v[36:37], v[112:113], v[38:39] op_sel_hi:[1,0,1]
    v_pk_fma_f32 v[22:23], v[36:37], v[114:115], v[22:23] op_sel_hi:[1,0,1] neg_lo:[0,1,0] neg_hi:[0,1,0]
    v_pk_fma_f32 v[38:39], v[20:21], v[114:115], v[38:39] op_sel_hi:[1,0,1]
    v_pk_mul_f32 v[184:185], v[20:21], v[8:9] op_sel_hi:[1,0]
    v_pk_mul_f32 v[186:187], v[36:37], v[8:9] op_sel_hi:[1,0] neg_lo:[0,1] neg_hi:[0,1]
    v_pk_fma_f32 v[184:185], v[36:37], v[14:15], v[184:185] op_sel_hi:[1,0,1] neg_lo:[0,1,0] neg_hi:[0,1,0]
    v_pk_fma_f32 v[186:187], v[20:21], v[14:15], v[186:187] op_sel_hi:[1,0,1] neg_lo:[0,1,0] neg_hi:[0,1,0]
    v_pk_mul_f32 v[184:185], v[184:185], v[156:157]
    v_pk_mul_f32 v[186:187], v[186:187], v[156:157]
    v_cvt_pk_bf16_f32 v170, v184, v185
    v_cvt_pk_bf16_f32 v178, v186, v187
    v_pk_fma_f32 v[24:25], v[22:23], v[112:113], v[24:25] op_sel_hi:[1,0,1]
    v_pk_fma_f32 v[40:41], v[38:39], v[112:113], v[40:41] op_sel_hi:[1,0,1]
    v_pk_fma_f32 v[24:25], v[38:39], v[114:115], v[24:25] op_sel_hi:[1,0,1] neg_lo:[0,1,0] neg_hi:[0,1,0]
    v_pk_fma_f32 v[40:41], v[22:23], v[114:115], v[40:41] op_sel_hi:[1,0,1]
    v_pk_mul_f32 v[184:185], v[22:23], v[8:9] op_sel_hi:[1,0]
    v_pk_mul_f32 v[186:187], v[38:39], v[8:9] op_sel_hi:[1,0] neg_lo:[0,1] neg_hi:[0,1]
    v_pk_fma_f32 v[184:185], v[38:39], v[14:15], v[184:185] op_sel_hi:[1,0,1] neg_lo:[0,1,0] neg_hi:[0,1,0]
    v_pk_fma_f32 v[186:187], v[22:23], v[14:15], v[186:187] op_sel_hi:[1,0,1] neg_lo:[0,1,0] neg_hi:[0,1,0]
    v_pk_mul_f32 v[184:185], v[184:185], v[158:159]
    v_pk_mul_f32 v[186:187], v[186:187], v[158:159]
    v_cvt_pk_bf16_f32 v171, v184, v185
    v_cvt_pk_bf16_f32 v179, v186, v187
    v_pk_fma_f32 v[26:27], v[24:25], v[112:113], v[26:27] op_sel_hi:[1,0,1]
    v_pk_fma_f32 v[42:43], v[40:41], v[112:113], v[42:43] op_sel_hi:[1,0,1]
    v_pk_fma_f32 v[26:27], v[40:41], v[114:115], v[26:27] op_sel_hi:[1,0,1] neg_lo:[0,1,0] neg_hi:[0,1,0]
    v_pk_fma_f32 v[42:43], v[24:25], v[114:115], v[42:43] op_sel_hi:[1,0,1]
    v_pk_mul_f32 v[184:185], v[24:25], v[8:9] op_sel_hi:[1,0]
    v_pk_mul_f32 v[186:187], v[40:41], v[8:9] op_sel_hi:[1,0] neg_lo:[0,1] neg_hi:[0,1]
    v_pk_fma_f32 v[184:185], v[40:41], v[14:15], v[184:185] op_sel_hi:[1,0,1] neg_lo:[0,1,0] neg_hi:[0,1,0]
    v_pk_fma_f32 v[186:187], v[24:25], v[14:15], v[186:187] op_sel_hi:[1,0,1] neg_lo:[0,1,0] neg_hi:[0,1,0]
    v_pk_mul_f32 v[184:185], v[184:185], v[160:161]
    v_pk_mul_f32 v[186:187], v[186:187], v[160:161]
    v_cvt_pk_bf16_f32 v172, v184, v185
    v_cvt_pk_bf16_f32 v180, v186, v187
    s_cmp_eq_u32 s84, 1
    s_cbranch_scc1 L_C_FC
    s_waitcnt vmcnt(0)
    buffer_store_dword v7, v5, s[76:79], s89 offen sc1
L_C_FC:
.p2align 3
    v_pk_fma_f32 v[28:29], v[26:27], v[112:113], v[28:29] op_sel_hi:[1,0,1]
    v_pk_fma_f32 v[44:45], v[42:43], v[112:113], v[44:45] op_sel_hi:[1,0,1]
    v_pk_fma_f32 v[28:29], v[42:43], v[114:115], v[28:29] op_sel_hi:[1,0,1] neg_lo:[0,1,0] neg_hi:[0,1,0]
    v_pk_fma_f32 v[44:45], v[26:27], v[114:115], v[44:45] op_sel_hi:[1,0,1]
    v_pk_mul_f32 v[184:185], v[26:27], v[8:9] op_sel_hi:[1,0]
    v_pk_mul_f32 v[186:187], v[42:43], v[8:9] op_sel_hi:[1,0] neg_lo:[0,1] neg_hi:[0,1]
    v_pk_fma_f32 v[184:185], v[42:43], v[14:15], v[184:185] op_sel_hi:[1,0,1] neg_lo:[0,1,0] neg_hi:[0,1,0]
    v_pk_fma_f32 v[186:187], v[26:27], v[14:15], v[186:187] op_sel_hi:[1,0,1] neg_lo:[0,1,0] neg_hi:[0,1,0]
    v_pk_mul_f32 v[184:185], v[184:185], v[162:163]
    v_pk_mul_f32 v[186:187], v[186:187], v[162:163]
    v_cvt_pk_bf16_f32 v173, v184, v185
    v_cvt_pk_bf16_f32 v181, v186, v187
    v_pk_fma_f32 v[30:31], v[28:29], v[112:113], v[30:31] op_sel_hi:[1,0,1]
    v_pk_fma_f32 v[46:47], v[44:45], v[112:113], v[46:47] op_sel_hi:[1,0,1]
    v_pk_fma_f32 v[30:31], v[44:45], v[114:115], v[30:31] op_sel_hi:[1,0,1] neg_lo:[0,1,0] neg_hi:[0,1,0]
    v_pk_fma_f32 v[46:47], v[28:29], v[114:115], v[46:47] op_sel_hi:[1,0,1]
    v_pk_mul_f32 v[184:185], v[28:29], v[8:9] op_sel_hi:[1,0]
    v_pk_mul_f32 v[186:187], v[44:45], v[8:9] op_sel_hi:[1,0] neg_lo:[0,1] neg_hi:[0,1]
    v_pk_fma_f32 v[184:185], v[44:45], v[14:15], v[184:185] op_sel_hi:[1,0,1] neg_lo:[0,1,0] neg_hi:[0,1,0]
    v_pk_fma_f32 v[186:187], v[28:29], v[14:15], v[186:187] op_sel_hi:[1,0,1] neg_lo:[0,1,0] neg_hi:[0,1,0]
    v_pk_mul_f32 v[184:185], v[184:185], v[164:165]
    v_pk_mul_f32 v[186:187], v[186:187], v[164:165]
    v_cvt_pk_bf16_f32 v174, v184, v185
    v_cvt_pk_bf16_f32 v182, v186, v187
    v_pk_mul_f32 v[184:185], v[30:31], v[8:9] op_sel_hi:[1,0]
    v_pk_mul_f32 v[186:187], v[46:47], v[8:9] op_sel_hi:[1,0] neg_lo:[0,1] neg_hi:[0,1]
    v_pk_fma_f32 v[184:185], v[46:47], v[14:15], v[184:185] op_sel_hi:[1,0,1] neg_lo:[0,1,0] neg_hi:[0,1,0]
    v_pk_fma_f32 v[186:187], v[30:31], v[14:15], v[186:187] op_sel_hi:[1,0,1] neg_lo:[0,1,0] neg_hi:[0,1,0]
    v_pk_mul_f32 v[184:185], v[184:185], v[166:167]
    v_pk_mul_f32 v[186:187], v[186:187], v[166:167]
    v_cvt_pk_bf16_f32 v175, v184, v185
    v_cvt_pk_bf16_f32 v183, v186, v187
    s_mul_i32 s13, s3, 2560
    s_add_u32 s13, s13, 153088
    v_mul_u32_u24 v128, 80, v1
    v_lshl_add_u32 v128, v2, 5, v128
    v_add_u32 v128, s13, v128
    v_bfe_u32 v129, v0, 2, 2
    v_lshl_add_u32 v129, v2, 3, v129
    v_mul_u32_u24 v129, 80, v129
    v_and_b32 v131, 1, v0
    v_lshl_add_u32 v129, v131, 5, v129
    v_bfe_u32 v131, v0, 4, 1
    v_lshl_add_u32 v129, v131, 4, v129
    v_bfe_u32 v131, v0, 1, 1
    v_lshl_add_u32 v129, v131, 3, v129
    v_add_u32 v129, s13, v129
    ds_write_b128 v128, v[168:171]
    ds_write_b128 v128, v[172:175] offset:16
    ds_read_b64_tr_b16 v[16:17], v129 offset:0
    ds_read_b64_tr_b16 v[18:19], v129 offset:320
    ds_read_b64_tr_b16 v[20:21], v129 offset:1280
    ds_read_b64_tr_b16 v[22:23], v129 offset:1600
    ds_write_b128 v128, v[176:179]
    ds_write_b128 v128, v[180:183] offset:16
    ds_read_b64_tr_b16 v[24:25], v129 offset:0
    ds_read_b64_tr_b16 v[26:27], v129 offset:320
    ds_read_b64_tr_b16 v[28:29], v129 offset:1280
    ds_read_b64_tr_b16 v[30:31], v129 offset:1600
    s_lshl_b32 s13, s5, 14
    s_add_u32 s13, s13, s88
    s_add_u32 s13, s13, 352256
    s_waitcnt lgkmcnt(8)
    buffer_store_dwordx4 v[16:19], v4, s[76:79], s13 offen sc1
    s_add_u32 s13, s13, 4096
    s_waitcnt lgkmcnt(6)
    buffer_store_dwordx4 v[20:23], v4, s[76:79], s13 offen sc1
    s_add_u32 s13, s13, 4096
    s_waitcnt lgkmcnt(2)
    buffer_store_dwordx4 v[24:27], v4, s[76:79], s13 offen sc1
    s_add_u32 s13, s13, 4096
    s_waitcnt lgkmcnt(0)
    buffer_store_dwordx4 v[28:31], v4, s[76:79], s13 offen sc1
    s_setprio 0
    s_waitcnt vmcnt(0)
    buffer_store_dword v7, v5, s[76:79], s89 offen offset:128 sc1
    v_lshrrev_b32 v131, 4, v0
    v_and_b32 v132, 1, v131
    v_lshlrev_b32 v132, 3, v132
    v_lshrrev_b32 v133, 1, v131
    v_add_u32 v128, v132, v133
    v_and_b32 v134, 15, v0
    s_lshl_b32 s90, s4, 7
    s_lshl_b32 s13, s7, 6
    s_add_u32 s90, s90, s13
    s_lshl_b32 s13, s3, 1
    s_add_u32 s90, s90, s13
    s_lshl_b32 s91, s90, 10
    s_lshl_b32 s13, s8, 7
    s_add_u32 s91, s91, s13
    v_lshlrev_b32 v132, 10, v128
    v_lshl_add_u32 v132, v134, 3, v132
    v_lshl_add_u32 v133, v134, 3, s13
    v_and_b32 v135, 3, v0
    v_lshlrev_b32 v135, 2, v135
    v_add_u32 v135, 163392, v135
    s_mov_b32 s15, 1600000
L_C_GW:
    ds_read_b32 v64, v135
    s_sub_u32 s15, s15, 1
    s_waitcnt lgkmcnt(0)
    v_cmp_eq_u32 vcc, 0, v64
    s_cmp_eq_u32 s15, 0
    s_cbranch_scc1 L_C_GOK
    s_cbranch_vccnz L_C_GW
L_C_GOK:
    s_lshl_b32 s13, s7, 3
    s_add_u32 s13, s13, s3
    s_lshl_b32 s13, s13, 5
    s_add_u32 s13, s13, 152320
    v_lshl_add_u32 v135, v131, 2, s13
    ds_read_b32 v64, v135 offset:0
    ds_read_b32 v66, v135 offset:16
    ds_read_b32 v68, v135 offset:128
    ds_read_b32 v70, v135 offset:144
    v_lshlrev_b32 v133, 3, v134
    v_add_u32 v133, 163424, v133
    ds_read_b64 v[40:41], v133
    ds_read_b64 v[42:43], v133 offset:128
    s_mul_i32 s13, s3, 1152
    s_add_u32 s13, s13, 99328
    v_mul_u32_u24 v132, 144, v131
    v_lshl_add_u32 v132, v134, 3, v132
    v_add_u32 v132, s13, v132
    ds_read_b64 v[32:33], v132 offset:0
    ds_read_b64 v[34:35], v132 offset:576
    ds_read_b64 v[36:37], v132 offset:4608
    ds_read_b64 v[38:39], v132 offset:5184
    s_lshl_b32 s13, s3, 11
    v_xor_b32 v152, v134, v131
    v_lshlrev_b32 v152, 4, v152
    v_lshl_add_u32 v152, v131, 8, v152
    v_add_u32 v152, s13, v152
    v_xor_b32 v153, 64, v152
    v_lshlrev_b32 v128, 11, v128
    v_lshl_add_u32 v128, v134, 4, v128
    s_lshl_b32 s90, s90, 11
    s_lshl_b32 s13, s8, 8
    s_add_u32 s90, s90, s13
    s_waitcnt vmcnt(0)
    s_waitcnt lgkmcnt(0)
    v_mul_f32 v64, 0.5, v64
    v_mul_f32 v66, 0.5, v66
    v_mul_f32 v68, 0.5, v68
    v_mul_f32 v70, 0.5, v70
    v_lshlrev_b32 v136, 16, v40
    v_and_b32 v137, 0xffff0000, v40
    v_lshlrev_b32 v140, 16, v42
    v_and_b32 v141, 0xffff0000, v42
    v_lshlrev_b32 v138, 16, v41
    v_and_b32 v139, 0xffff0000, v41
    v_lshlrev_b32 v142, 16, v43
    v_and_b32 v143, 0xffff0000, v43
    v_sub_f32 v149, 1.0, v64
    v_cvt_pk_bf16_f32 v149, v149, v149
    v_and_b32 v149, 0xffff0000, v149
    v_lshlrev_b32 v144, 16, v32
    v_and_b32 v145, 0xffff0000, v32
    v_mul_f32 v144, v144, v136
    v_mul_f32 v145, v145, v137
    v_cvt_pk_bf16_f32 v150, v144, v145
    v_lshlrev_b32 v144, 16, v150
    v_and_b32 v145, 0xffff0000, v150
    v_mul_f32 v48, v140, v149
    v_fmac_f32 v48, v144, v64
    v_mul_f32 v49, v141, v149
    v_fmac_f32 v49, v145, v64
    v_lshlrev_b32 v146, 16, v33
    v_and_b32 v147, 0xffff0000, v33
    v_mul_f32 v146, v146, v138
    v_mul_f32 v147, v147, v139
    v_cvt_pk_bf16_f32 v150, v146, v147
    v_lshlrev_b32 v146, 16, v150
    v_and_b32 v147, 0xffff0000, v150
    v_mul_f32 v50, v142, v149
    v_fmac_f32 v50, v146, v64
    v_mul_f32 v51, v143, v149
    v_fmac_f32 v51, v147, v64
    v_sub_f32 v149, 1.0, v66
    v_cvt_pk_bf16_f32 v149, v149, v149
    v_and_b32 v149, 0xffff0000, v149
    v_lshlrev_b32 v144, 16, v34
    v_and_b32 v145, 0xffff0000, v34
    v_mul_f32 v144, v144, v136
    v_mul_f32 v145, v145, v137
    v_cvt_pk_bf16_f32 v150, v144, v145
    v_lshlrev_b32 v144, 16, v150
    v_and_b32 v145, 0xffff0000, v150
    v_mul_f32 v52, v140, v149
    v_fmac_f32 v52, v144, v66
    v_mul_f32 v53, v141, v149
    v_fmac_f32 v53, v145, v66
    v_lshlrev_b32 v146, 16, v35
    v_and_b32 v147, 0xffff0000, v35
    v_mul_f32 v146, v146, v138
    v_mul_f32 v147, v147, v139
    v_cvt_pk_bf16_f32 v150, v146, v147
    v_lshlrev_b32 v146, 16, v150
    v_and_b32 v147, 0xffff0000, v150
    v_mul_f32 v54, v142, v149
    v_fmac_f32 v54, v146, v66
    v_mul_f32 v55, v143, v149
    v_fmac_f32 v55, v147, v66
    v_sub_f32 v149, 1.0, v68
    v_cvt_pk_bf16_f32 v149, v149, v149
    v_and_b32 v149, 0xffff0000, v149
    v_lshlrev_b32 v144, 16, v36
    v_and_b32 v145, 0xffff0000, v36
    v_mul_f32 v144, v144, v136
    v_mul_f32 v145, v145, v137
    v_cvt_pk_bf16_f32 v150, v144, v145
    v_lshlrev_b32 v144, 16, v150
    v_and_b32 v145, 0xffff0000, v150
    v_mul_f32 v56, v140, v149
    v_fmac_f32 v56, v144, v68
    v_mul_f32 v57, v141, v149
    v_fmac_f32 v57, v145, v68
    v_lshlrev_b32 v146, 16, v37
    v_and_b32 v147, 0xffff0000, v37
    v_mul_f32 v146, v146, v138
    v_mul_f32 v147, v147, v139
    v_cvt_pk_bf16_f32 v150, v146, v147
    v_lshlrev_b32 v146, 16, v150
    v_and_b32 v147, 0xffff0000, v150
    v_mul_f32 v58, v142, v149
    v_fmac_f32 v58, v146, v68
    v_mul_f32 v59, v143, v149
    v_fmac_f32 v59, v147, v68
    v_sub_f32 v149, 1.0, v70
    v_cvt_pk_bf16_f32 v149, v149, v149
    v_and_b32 v149, 0xffff0000, v149
    v_lshlrev_b32 v144, 16, v38
    v_and_b32 v145, 0xffff0000, v38
    v_mul_f32 v144, v144, v136
    v_mul_f32 v145, v145, v137
    v_cvt_pk_bf16_f32 v150, v144, v145
    v_lshlrev_b32 v144, 16, v150
    v_and_b32 v145, 0xffff0000, v150
    v_mul_f32 v60, v140, v149
    v_fmac_f32 v60, v144, v70
    v_mul_f32 v61, v141, v149
    v_fmac_f32 v61, v145, v70
    v_lshlrev_b32 v146, 16, v39
    v_and_b32 v147, 0xffff0000, v39
    v_mul_f32 v146, v146, v138
    v_mul_f32 v147, v147, v139
    v_cvt_pk_bf16_f32 v150, v146, v147
    v_lshlrev_b32 v146, 16, v150
    v_and_b32 v147, 0xffff0000, v150
    v_mul_f32 v62, v142, v149
    v_fmac_f32 v62, v146, v70
    v_mul_f32 v63, v143, v149
    v_fmac_f32 v63, v147, v70
    s_mov_b32 s80, s46
    s_mov_b32 s81, s47
    s_mov_b32 s82, 4194304
    s_mov_b32 s83, 0x20000
L_C_YS:
    s_nop 0
    s_barrier
    ds_read_b128 v[64:67], v152 offset:0
    ds_read_b128 v[68:71], v152 offset:8192
    ds_read_b128 v[72:75], v152 offset:16384
    ds_read_b128 v[76:79], v152 offset:24576
    ds_read_b128 v[80:83], v153 offset:1024
    ds_read_b128 v[84:87], v153 offset:9216
    ds_read_b128 v[88:91], v153 offset:17408
    ds_read_b128 v[92:95], v153 offset:25600
    s_add_u32 s14, s90, 0
    s_waitcnt lgkmcnt(6)
    v_pk_add_f32 v[48:49], v[48:49], v[64:65]
    v_pk_add_f32 v[50:51], v[50:51], v[66:67]
    v_pk_add_f32 v[48:49], v[48:49], v[68:69]
    v_pk_add_f32 v[50:51], v[50:51], v[70:71]
    s_waitcnt lgkmcnt(4)
    v_pk_add_f32 v[48:49], v[48:49], v[72:73]
    v_pk_add_f32 v[50:51], v[50:51], v[74:75]
    v_pk_add_f32 v[48:49], v[48:49], v[76:77]
    v_pk_add_f32 v[50:51], v[50:51], v[78:79]
    buffer_store_dwordx4 v[48:51], v128, s[80:83], s14 offen sc1
    s_add_u32 s14, s90, 32768
    s_waitcnt lgkmcnt(2)
    v_pk_add_f32 v[52:53], v[52:53], v[80:81]
    v_pk_add_f32 v[54:55], v[54:55], v[82:83]
    v_pk_add_f32 v[52:53], v[52:53], v[84:85]
    v_pk_add_f32 v[54:55], v[54:55], v[86:87]
    s_waitcnt lgkmcnt(0)
    v_pk_add_f32 v[52:53], v[52:53], v[88:89]
    v_pk_add_f32 v[54:55], v[54:55], v[90:91]
    v_pk_add_f32 v[52:53], v[52:53], v[92:93]
    v_pk_add_f32 v[54:55], v[54:55], v[94:95]
    buffer_store_dwordx4 v[52:55], v128, s[80:83], s14 offen sc1
    s_barrier
    ds_read_b128 v[96:99], v152 offset:32768
    ds_read_b128 v[100:103], v152 offset:40960
    ds_read_b128 v[104:107], v152 offset:49152
    ds_read_b128 v[108:111], v152 offset:57344
    ds_read_b128 v[112:115], v153 offset:33792
    ds_read_b128 v[116:119], v153 offset:41984
    ds_read_b128 v[120:123], v153 offset:50176
    ds_read_b128 v[124:127], v153 offset:58368
    s_add_u32 s14, s90, 65536
    s_waitcnt lgkmcnt(6)
    v_pk_add_f32 v[56:57], v[56:57], v[96:97]
    v_pk_add_f32 v[58:59], v[58:59], v[98:99]
    v_pk_add_f32 v[56:57], v[56:57], v[100:101]
    v_pk_add_f32 v[58:59], v[58:59], v[102:103]
    s_waitcnt lgkmcnt(4)
    v_pk_add_f32 v[56:57], v[56:57], v[104:105]
    v_pk_add_f32 v[58:59], v[58:59], v[106:107]
    v_pk_add_f32 v[56:57], v[56:57], v[108:109]
    v_pk_add_f32 v[58:59], v[58:59], v[110:111]
    buffer_store_dwordx4 v[56:59], v128, s[80:83], s14 offen sc1
    s_add_u32 s14, s90, 98304
    s_waitcnt lgkmcnt(2)
    v_pk_add_f32 v[60:61], v[60:61], v[112:113]
    v_pk_add_f32 v[62:63], v[62:63], v[114:115]
    v_pk_add_f32 v[60:61], v[60:61], v[116:117]
    v_pk_add_f32 v[62:63], v[62:63], v[118:119]
    s_waitcnt lgkmcnt(0)
    v_pk_add_f32 v[60:61], v[60:61], v[120:121]
    v_pk_add_f32 v[62:63], v[62:63], v[122:123]
    v_pk_add_f32 v[60:61], v[60:61], v[124:125]
    v_pk_add_f32 v[62:63], v[62:63], v[126:127]
    buffer_store_dwordx4 v[60:63], v128, s[80:83], s14 offen sc1
    s_or_b32 s13, s5, s3
    s_cmp_lg_u32 s13, 0
    s_cbranch_scc1 L_C_DONE
    s_lshl_b32 s13, s4, 7
    s_add_u32 s13, s13, 10878976
    buffer_store_dword v7, v5, s[76:79], s13 offen sc1
L_C_DONE:
    s_endpgm
L_CODE_END:
.section .rodata,"a"
.p2align 6
.amdhsa_kernel gated_mix__ssm_conv_s5__mixer_channel_mlp__prompt_kernel
  .amdhsa_next_free_vgpr 256
  .amdhsa_next_free_sgpr 102
  .amdhsa_accum_offset 256
  .amdhsa_group_segment_fixed_size 0
  .amdhsa_kernarg_size 144
  .amdhsa_user_sgpr_count 2
  .amdhsa_user_sgpr_kernarg_segment_ptr 1
  .amdhsa_system_sgpr_workgroup_id_x 1
.end_amdhsa_kernel
```
